```python
import torch

def _softmax(x, axis=-1):
    return torch.softmax(x, dim=axis)
def _gelu(x):
    return torch.nn.functional.gelu(x, approximate="tanh")
def _silu(x):
    return torch.nn.functional.silu(x)
def _sigmoid(x):
    return torch.sigmoid(x)
def _layernorm(x, axis=-1, eps=1e-5):
    m = x.mean(dim=axis, keepdim=True)
    v = x.var(dim=axis, keepdim=True, unbiased=False)
    return (x - m) / torch.sqrt(v + eps)
def _scatter_add(tgt, idx, src, axis=0):
    return tgt.clone().index_add_(axis, idx, src)
def _segment_sum(src, seg, n):
    out = torch.zeros((n,) + src.shape[1:], dtype=src.dtype)
    return out.index_add_(0, seg, src)
def _pad(x, pw):
    flat = tuple(v for pair in reversed(pw) for v in pair)
    return torch.nn.functional.pad(x, flat)

kernel_name = 'standalone__softmax_full_bidir__decode'

def setup_inputs():

    _w = (lambda a: (lambda t: t.to(torch.bfloat16) if t.is_floating_point() else t)(torch.as_tensor(a)))
    B, H, Sq, Skv, Dh = 2, 32, 1, 16384, 128
    return {
        "q": _w((lambda *s: torch.randn(*s, dtype=torch.bfloat16) * 0.8)(B, H, Sq, Dh)),
        "k": _w((lambda *s: torch.randn(*s, dtype=torch.bfloat16) * 0.8)(B, H, Skv, Dh)),
        "v": _w((lambda *s: torch.randn(*s, dtype=torch.bfloat16) * 0.05)(B, H, Skv, Dh)),
    }

def reference(q, k, v):
    scale = q.shape[-1] ** -0.5
    scores = torch.einsum('bhqd,bhkd->bhqk', q, k) * scale
    attn = _softmax(scores, axis=-1)
    return torch.einsum('bhqk,bhkd->bhqd', attn, v)
```

```asm
; @launch grid=(256,1,1) block=(64,1,1) lds=90000
.amdgcn_target "amdgcn-amd-amdhsa--gfx950"
.text
.globl standalone__softmax_full_bidir__decode_kernel
.p2align 8
.type standalone__softmax_full_bidir__decode_kernel,@function
standalone__softmax_full_bidir__decode_kernel:
    s_load_dwordx2 s[8:9], s[0:1], 8
    s_load_dwordx2 s[16:17], s[0:1], 0
    s_load_dwordx2 s[12:13], s[0:1], 16
    s_load_dwordx2 s[20:21], s[0:1], 24
    s_load_dwordx2 s[24:25], s[0:1], 32
    s_load_dwordx2 s[28:29], s[0:1], 40
    s_memrealtime s[84:85]
    s_cmp_ge_u32 s2, 256
    s_cbranch_scc1 L_end
    v_lshlrev_b32 v2, 4, v0
    s_lshr_b32 s41, s2, 2
    s_lshl_b32 s47, s41, 22
    s_bfe_u32 s44, s2, 65536
    s_lshl_b32 s44, s44, 15
    s_or_b32 s47, s47, s44
    s_bfe_u32 s44, s2, 65537
    s_lshl_b32 s44, s44, 21
    s_or_b32 s47, s47, s44
    s_mov_b32 s10, 0x10000000
    s_mov_b32 s11, 0x00020000
    s_mov_b32 s18, 16384
    s_mov_b32 s19, 0x00020000
    v_and_b32 v30, 0xf0, v2
    s_lshl_b32 s46, s41, 8
    s_getpc_b64 s[88:89]
L_pcd:
    s_add_u32 s88, s88, L_pro-L_pcd
    s_addc_u32 s89, s89, 0
    v_lshlrev_b32 v29, 7, v0
    v_min_u32 v29, L_end-L_pro-4, v29
    global_load_dword v47, v29, s[88:89]
    v_lshlrev_b32 v29, 7, v0
    v_add_u32 v29, 8192, v29
    v_min_u32 v29, L_end-L_pro-4, v29
    global_load_dword v47, v29, s[88:89]
    v_lshlrev_b32 v29, 7, v0
    v_add_u32 v29, 16384, v29
    v_min_u32 v29, L_end-L_pro-4, v29
    global_load_dword v47, v29, s[88:89]
    s_waitcnt lgkmcnt(0)
L_pro:
    buffer_load_dwordx4 v[4:7], v30, s[16:19], s46 offen
    buffer_load_dwordx4 v[84:87], v2, s[8:11], s47 offen nt
    buffer_load_dwordx4 v[88:91], v2, s[8:11], s47 offen offset:1024 nt
    buffer_load_dwordx4 v[92:95], v2, s[8:11], s47 offen offset:2048 nt
    buffer_load_dwordx4 v[96:99], v2, s[8:11], s47 offen offset:3072 nt
    s_add_u32 s44, s47, 4096
    buffer_load_dwordx4 v[100:103], v2, s[8:11], s44 offen nt
    buffer_load_dwordx4 v[104:107], v2, s[8:11], s44 offen offset:1024 nt
    buffer_load_dwordx4 v[108:111], v2, s[8:11], s44 offen offset:2048 nt
    buffer_load_dwordx4 v[112:115], v2, s[8:11], s44 offen offset:3072 nt
    s_add_u32 s44, s47, 8192
    buffer_load_dwordx4 v[116:119], v2, s[8:11], s44 offen nt
    buffer_load_dwordx4 v[120:123], v2, s[8:11], s44 offen offset:1024 nt
    buffer_load_dwordx4 v[124:127], v2, s[8:11], s44 offen offset:2048 nt
    buffer_load_dwordx4 v[128:131], v2, s[8:11], s44 offen offset:3072 nt
    s_add_u32 s44, s47, 12288
    buffer_load_dwordx4 v[132:135], v2, s[8:11], s44 offen nt
    buffer_load_dwordx4 v[136:139], v2, s[8:11], s44 offen offset:1024 nt
    buffer_load_dwordx4 v[140:143], v2, s[8:11], s44 offen offset:2048 nt
    buffer_load_dwordx4 v[144:147], v2, s[8:11], s44 offen offset:3072 nt
    s_add_u32 s44, s47, 16384
    buffer_load_dwordx4 v[148:151], v2, s[8:11], s44 offen nt
    buffer_load_dwordx4 v[152:155], v2, s[8:11], s44 offen offset:1024 nt
    buffer_load_dwordx4 v[156:159], v2, s[8:11], s44 offen offset:2048 nt
    buffer_load_dwordx4 v[160:163], v2, s[8:11], s44 offen offset:3072 nt
    s_add_u32 s44, s47, 20480
    buffer_load_dwordx4 v[164:167], v2, s[8:11], s44 offen nt
    buffer_load_dwordx4 v[168:171], v2, s[8:11], s44 offen offset:1024 nt
    buffer_load_dwordx4 v[172:175], v2, s[8:11], s44 offen offset:2048 nt
    buffer_load_dwordx4 v[176:179], v2, s[8:11], s44 offen offset:3072 nt
    s_add_u32 s44, s47, 24576
    buffer_load_dwordx4 v[180:183], v2, s[8:11], s44 offen nt
    buffer_load_dwordx4 v[184:187], v2, s[8:11], s44 offen offset:1024 nt
    buffer_load_dwordx4 v[188:191], v2, s[8:11], s44 offen offset:2048 nt
    buffer_load_dwordx4 v[192:195], v2, s[8:11], s44 offen offset:3072 nt
    s_add_u32 s44, s47, 28672
    buffer_load_dwordx4 v[196:199], v2, s[8:11], s44 offen nt
    buffer_load_dwordx4 v[200:203], v2, s[8:11], s44 offen offset:1024 nt
    buffer_load_dwordx4 v[204:207], v2, s[8:11], s44 offen offset:2048 nt
    buffer_load_dwordx4 v[208:211], v2, s[8:11], s44 offen offset:3072 nt
    s_mov_b32 s26, 256
    s_mov_b32 s27, 0x00020000
    s_mov_b32 s30, 0x100000
    s_mov_b32 s31, 0x00020000
    s_mov_b64 s[32:33], s[8:9]
    s_mov_b32 s34, 0x10000000
    s_mov_b32 s35, 0x00020000
    s_mov_b32 s22, 16384
    s_mov_b32 s23, 0x00020000
    s_mov_b32 s40, 0x3e0293ee
    s_mov_b32 s52, 0xaaaaaaaa
    s_mov_b32 s53, 0xaaaaaaaa
    s_mov_b32 s54, 0xcccccccc
    s_mov_b32 s55, 0xcccccccc
    s_mov_b32 s38, 0
    s_mov_b32 s37, s47
    s_mov_b32 s49, 1
    s_mov_b32 s90, 0x100000
    s_lshl_b32 s43, s84, 4
    s_add_u32 s43, s43, 4294967232
    v_lshlrev_b32 v3, 3, v0
    v_and_b32 v29, 15, v0
    v_and_b32 v30, 1, v0
    v_lshlrev_b32 v30, 4, v30
    v_mov_b32 v31, 0xffff
    v_lshlrev_b32 v31, v30, v31
    v_lshrrev_b32 v29, 1, v29
    v_cmp_eq_u32 vcc, 0, v29
    s_nop 1
    v_cndmask_b32 v8, 0, v31, vcc
    v_cmp_eq_u32 vcc, 1, v29
    s_nop 1
    v_cndmask_b32 v9, 0, v31, vcc
    v_cmp_eq_u32 vcc, 2, v29
    s_nop 1
    v_cndmask_b32 v10, 0, v31, vcc
    v_cmp_eq_u32 vcc, 3, v29
    s_nop 1
    v_cndmask_b32 v11, 0, v31, vcc
    v_mov_b32 v12, 0
    v_mov_b32 v13, 0
    v_mov_b32 v14, 0
    v_mov_b32 v15, 0
    v_mov_b32 v28, 0
    v_mov_b32 v36, 0xff7fffff
L_ktop:
    s_memrealtime s[86:87]
    s_add_u32 s37, s37, 65536
    s_cmp_lg_u32 s38, 31
    s_cbranch_scc1 L_kgo
    s_mov_b64 s[32:33], s[12:13]
    s_mov_b32 s37, s47
L_kgo:
    s_cmp_eq_u32 s49, 1
    s_cbranch_scc1 L_kb1
    s_cmp_eq_u32 s49, 0
    s_cbranch_scc1 L_kb0
    s_cmp_eq_u32 s49, 2
    s_cbranch_scc1 L_kb2
    s_cmp_eq_u32 s49, 3
    s_cbranch_scc1 L_kb3
    s_branch L_kb4
L_kb1:
    s_waitcnt vmcnt(19)
    v_dot2_f32_bf16 v24, v84, v4, 0
    v_dot2_f32_bf16 v24, v85, v5, v24
    v_dot2_f32_bf16 v24, v86, v6, v24
    v_dot2_f32_bf16 v24, v87, v7, v24
    buffer_load_dwordx4 v[84:87], v2, s[32:35], s37 offen nt
    s_waitcnt vmcnt(19)
    v_dot2_f32_bf16 v25, v88, v4, 0
    v_dot2_f32_bf16 v25, v89, v5, v25
    v_dot2_f32_bf16 v25, v90, v6, v25
    v_dot2_f32_bf16 v25, v91, v7, v25
    buffer_load_dwordx4 v[88:91], v2, s[32:35], s37 offen offset:1024 nt
    s_waitcnt vmcnt(19)
    v_dot2_f32_bf16 v26, v92, v4, 0
    v_dot2_f32_bf16 v26, v93, v5, v26
    v_dot2_f32_bf16 v26, v94, v6, v26
    v_dot2_f32_bf16 v26, v95, v7, v26
    buffer_load_dwordx4 v[92:95], v2, s[32:35], s37 offen offset:2048 nt
    s_waitcnt vmcnt(19)
    v_dot2_f32_bf16 v27, v96, v4, 0
    v_dot2_f32_bf16 v27, v97, v5, v27
    v_dot2_f32_bf16 v27, v98, v6, v27
    v_dot2_f32_bf16 v27, v99, v7, v27
    buffer_load_dwordx4 v[96:99], v2, s[32:35], s37 offen offset:3072 nt
    s_nop 1
    v_add_f32_dpp v24, v24, v24 row_mirror row_mask:0xf bank_mask:0x3
    v_add_f32_dpp v25, v25, v25 row_mirror row_mask:0xf bank_mask:0x3
    v_add_f32_dpp v24, v26, v26 row_mirror row_mask:0xf bank_mask:0xc
    v_add_f32_dpp v25, v27, v27 row_mirror row_mask:0xf bank_mask:0xc
    s_nop 0
    v_add_f32_dpp v32, v24, v24 row_half_mirror row_mask:0xf bank_mask:0x5
    v_add_f32_dpp v32, v25, v25 row_half_mirror row_mask:0xf bank_mask:0xa
    s_waitcnt vmcnt(19)
    v_dot2_f32_bf16 v24, v100, v4, 0
    v_dot2_f32_bf16 v24, v101, v5, v24
    v_dot2_f32_bf16 v24, v102, v6, v24
    v_dot2_f32_bf16 v24, v103, v7, v24
    s_add_u32 s44, s37, 4096
    buffer_load_dwordx4 v[100:103], v2, s[32:35], s44 offen nt
    s_waitcnt vmcnt(19)
    v_dot2_f32_bf16 v25, v104, v4, 0
    v_dot2_f32_bf16 v25, v105, v5, v25
    v_dot2_f32_bf16 v25, v106, v6, v25
    v_dot2_f32_bf16 v25, v107, v7, v25
    buffer_load_dwordx4 v[104:107], v2, s[32:35], s44 offen offset:1024 nt
    s_waitcnt vmcnt(19)
    v_dot2_f32_bf16 v26, v108, v4, 0
    v_dot2_f32_bf16 v26, v109, v5, v26
    v_dot2_f32_bf16 v26, v110, v6, v26
    v_dot2_f32_bf16 v26, v111, v7, v26
    buffer_load_dwordx4 v[108:111], v2, s[32:35], s44 offen offset:2048 nt
    s_waitcnt vmcnt(19)
    v_dot2_f32_bf16 v27, v112, v4, 0
    v_dot2_f32_bf16 v27, v113, v5, v27
    v_dot2_f32_bf16 v27, v114, v6, v27
    v_dot2_f32_bf16 v27, v115, v7, v27
    buffer_load_dwordx4 v[112:115], v2, s[32:35], s44 offen offset:3072 nt
    s_nop 1
    v_add_f32_dpp v24, v24, v24 row_mirror row_mask:0xf bank_mask:0x3
    v_add_f32_dpp v25, v25, v25 row_mirror row_mask:0xf bank_mask:0x3
    v_add_f32_dpp v24, v26, v26 row_mirror row_mask:0xf bank_mask:0xc
    v_add_f32_dpp v25, v27, v27 row_mirror row_mask:0xf bank_mask:0xc
    s_nop 0
    v_add_f32_dpp v33, v24, v24 row_half_mirror row_mask:0xf bank_mask:0x5
    v_add_f32_dpp v33, v25, v25 row_half_mirror row_mask:0xf bank_mask:0xa
    s_waitcnt vmcnt(19)
    v_dot2_f32_bf16 v24, v116, v4, 0
    v_dot2_f32_bf16 v24, v117, v5, v24
    v_dot2_f32_bf16 v24, v118, v6, v24
    v_dot2_f32_bf16 v24, v119, v7, v24
    s_add_u32 s44, s37, 8192
    buffer_load_dwordx4 v[116:119], v2, s[32:35], s44 offen nt
    s_waitcnt vmcnt(19)
    v_dot2_f32_bf16 v25, v120, v4, 0
    v_dot2_f32_bf16 v25, v121, v5, v25
    v_dot2_f32_bf16 v25, v122, v6, v25
    v_dot2_f32_bf16 v25, v123, v7, v25
    buffer_load_dwordx4 v[120:123], v2, s[32:35], s44 offen offset:1024 nt
    s_waitcnt vmcnt(19)
    v_dot2_f32_bf16 v26, v124, v4, 0
    v_dot2_f32_bf16 v26, v125, v5, v26
    v_dot2_f32_bf16 v26, v126, v6, v26
    v_dot2_f32_bf16 v26, v127, v7, v26
    buffer_load_dwordx4 v[124:127], v2, s[32:35], s44 offen offset:2048 nt
    s_waitcnt vmcnt(19)
    v_dot2_f32_bf16 v27, v128, v4, 0
    v_dot2_f32_bf16 v27, v129, v5, v27
    v_dot2_f32_bf16 v27, v130, v6, v27
    v_dot2_f32_bf16 v27, v131, v7, v27
    buffer_load_dwordx4 v[128:131], v2, s[32:35], s44 offen offset:3072 nt
    s_nop 1
    v_add_f32_dpp v24, v24, v24 row_mirror row_mask:0xf bank_mask:0x3
    v_add_f32_dpp v25, v25, v25 row_mirror row_mask:0xf bank_mask:0x3
    v_add_f32_dpp v24, v26, v26 row_mirror row_mask:0xf bank_mask:0xc
    v_add_f32_dpp v25, v27, v27 row_mirror row_mask:0xf bank_mask:0xc
    s_nop 0
    v_add_f32_dpp v34, v24, v24 row_half_mirror row_mask:0xf bank_mask:0x5
    v_add_f32_dpp v34, v25, v25 row_half_mirror row_mask:0xf bank_mask:0xa
    s_waitcnt vmcnt(19)
    v_dot2_f32_bf16 v24, v132, v4, 0
    v_dot2_f32_bf16 v24, v133, v5, v24
    v_dot2_f32_bf16 v24, v134, v6, v24
    v_dot2_f32_bf16 v24, v135, v7, v24
    s_add_u32 s44, s37, 12288
    buffer_load_dwordx4 v[132:135], v2, s[32:35], s44 offen nt
    s_waitcnt vmcnt(19)
    v_dot2_f32_bf16 v25, v136, v4, 0
    v_dot2_f32_bf16 v25, v137, v5, v25
    v_dot2_f32_bf16 v25, v138, v6, v25
    v_dot2_f32_bf16 v25, v139, v7, v25
    buffer_load_dwordx4 v[136:139], v2, s[32:35], s44 offen offset:1024 nt
    s_waitcnt vmcnt(19)
    v_dot2_f32_bf16 v26, v140, v4, 0
    v_dot2_f32_bf16 v26, v141, v5, v26
    v_dot2_f32_bf16 v26, v142, v6, v26
    v_dot2_f32_bf16 v26, v143, v7, v26
    buffer_load_dwordx4 v[140:143], v2, s[32:35], s44 offen offset:2048 nt
    s_waitcnt vmcnt(19)
    v_dot2_f32_bf16 v27, v144, v4, 0
    v_dot2_f32_bf16 v27, v145, v5, v27
    v_dot2_f32_bf16 v27, v146, v6, v27
    v_dot2_f32_bf16 v27, v147, v7, v27
    buffer_load_dwordx4 v[144:147], v2, s[32:35], s44 offen offset:3072 nt
    s_nop 1
    v_add_f32_dpp v24, v24, v24 row_mirror row_mask:0xf bank_mask:0x3
    v_add_f32_dpp v25, v25, v25 row_mirror row_mask:0xf bank_mask:0x3
    v_add_f32_dpp v24, v26, v26 row_mirror row_mask:0xf bank_mask:0xc
    v_add_f32_dpp v25, v27, v27 row_mirror row_mask:0xf bank_mask:0xc
    s_nop 0
    v_add_f32_dpp v35, v24, v24 row_half_mirror row_mask:0xf bank_mask:0x5
    v_add_f32_dpp v35, v25, v25 row_half_mirror row_mask:0xf bank_mask:0xa
    v_cndmask_b32 v24, v33, v32, s[52:53]
    v_cndmask_b32 v25, v35, v34, s[52:53]
    v_cndmask_b32 v26, v32, v33, s[52:53]
    v_cndmask_b32 v27, v34, v35, s[52:53]
    s_nop 0
    v_add_f32_dpp v26, v24, v26 quad_perm:[1,0,3,2] row_mask:0xf bank_mask:0xf
    v_add_f32_dpp v27, v25, v27 quad_perm:[1,0,3,2] row_mask:0xf bank_mask:0xf
    v_cndmask_b32 v24, v27, v26, s[54:55]
    v_cndmask_b32 v25, v26, v27, s[54:55]
    s_nop 1
    v_add_f32_dpp v38, v24, v25 quad_perm:[2,3,0,1] row_mask:0xf bank_mask:0xf
    s_waitcnt vmcnt(19)
    v_dot2_f32_bf16 v24, v148, v4, 0
    v_dot2_f32_bf16 v24, v149, v5, v24
    v_dot2_f32_bf16 v24, v150, v6, v24
    v_dot2_f32_bf16 v24, v151, v7, v24
    s_add_u32 s44, s37, 16384
    buffer_load_dwordx4 v[148:151], v2, s[32:35], s44 offen nt
    s_waitcnt vmcnt(19)
    v_dot2_f32_bf16 v25, v152, v4, 0
    v_dot2_f32_bf16 v25, v153, v5, v25
    v_dot2_f32_bf16 v25, v154, v6, v25
    v_dot2_f32_bf16 v25, v155, v7, v25
    buffer_load_dwordx4 v[152:155], v2, s[32:35], s44 offen offset:1024 nt
    s_waitcnt vmcnt(19)
    v_dot2_f32_bf16 v26, v156, v4, 0
    v_dot2_f32_bf16 v26, v157, v5, v26
    v_dot2_f32_bf16 v26, v158, v6, v26
    v_dot2_f32_bf16 v26, v159, v7, v26
    buffer_load_dwordx4 v[156:159], v2, s[32:35], s44 offen offset:2048 nt
    s_waitcnt vmcnt(19)
    v_dot2_f32_bf16 v27, v160, v4, 0
    v_dot2_f32_bf16 v27, v161, v5, v27
    v_dot2_f32_bf16 v27, v162, v6, v27
    v_dot2_f32_bf16 v27, v163, v7, v27
    buffer_load_dwordx4 v[160:163], v2, s[32:35], s44 offen offset:3072 nt
    s_nop 1
    v_add_f32_dpp v24, v24, v24 row_mirror row_mask:0xf bank_mask:0x3
    v_add_f32_dpp v25, v25, v25 row_mirror row_mask:0xf bank_mask:0x3
    v_add_f32_dpp v24, v26, v26 row_mirror row_mask:0xf bank_mask:0xc
    v_add_f32_dpp v25, v27, v27 row_mirror row_mask:0xf bank_mask:0xc
    s_nop 0
    v_add_f32_dpp v32, v24, v24 row_half_mirror row_mask:0xf bank_mask:0x5
    v_add_f32_dpp v32, v25, v25 row_half_mirror row_mask:0xf bank_mask:0xa
    s_waitcnt vmcnt(19)
    v_dot2_f32_bf16 v24, v164, v4, 0
    v_dot2_f32_bf16 v24, v165, v5, v24
    v_dot2_f32_bf16 v24, v166, v6, v24
    v_dot2_f32_bf16 v24, v167, v7, v24
    s_add_u32 s44, s37, 20480
    buffer_load_dwordx4 v[164:167], v2, s[32:35], s44 offen nt
    s_waitcnt vmcnt(19)
    v_dot2_f32_bf16 v25, v168, v4, 0
    v_dot2_f32_bf16 v25, v169, v5, v25
    v_dot2_f32_bf16 v25, v170, v6, v25
    v_dot2_f32_bf16 v25, v171, v7, v25
    buffer_load_dwordx4 v[168:171], v2, s[32:35], s44 offen offset:1024 nt
    s_waitcnt vmcnt(19)
    v_dot2_f32_bf16 v26, v172, v4, 0
    v_dot2_f32_bf16 v26, v173, v5, v26
    v_dot2_f32_bf16 v26, v174, v6, v26
    v_dot2_f32_bf16 v26, v175, v7, v26
    buffer_load_dwordx4 v[172:175], v2, s[32:35], s44 offen offset:2048 nt
    s_waitcnt vmcnt(19)
    v_dot2_f32_bf16 v27, v176, v4, 0
    v_dot2_f32_bf16 v27, v177, v5, v27
    v_dot2_f32_bf16 v27, v178, v6, v27
    v_dot2_f32_bf16 v27, v179, v7, v27
    buffer_load_dwordx4 v[176:179], v2, s[32:35], s44 offen offset:3072 nt
    s_nop 1
    v_add_f32_dpp v24, v24, v24 row_mirror row_mask:0xf bank_mask:0x3
    v_add_f32_dpp v25, v25, v25 row_mirror row_mask:0xf bank_mask:0x3
    v_add_f32_dpp v24, v26, v26 row_mirror row_mask:0xf bank_mask:0xc
    v_add_f32_dpp v25, v27, v27 row_mirror row_mask:0xf bank_mask:0xc
    s_nop 0
    v_add_f32_dpp v33, v24, v24 row_half_mirror row_mask:0xf bank_mask:0x5
    v_add_f32_dpp v33, v25, v25 row_half_mirror row_mask:0xf bank_mask:0xa
    s_waitcnt vmcnt(19)
    v_dot2_f32_bf16 v24, v180, v4, 0
    v_dot2_f32_bf16 v24, v181, v5, v24
    v_dot2_f32_bf16 v24, v182, v6, v24
    v_dot2_f32_bf16 v24, v183, v7, v24
    s_add_u32 s44, s37, 24576
    buffer_load_dwordx4 v[180:183], v2, s[32:35], s44 offen nt
    s_waitcnt vmcnt(19)
    v_dot2_f32_bf16 v25, v184, v4, 0
    v_dot2_f32_bf16 v25, v185, v5, v25
    v_dot2_f32_bf16 v25, v186, v6, v25
    v_dot2_f32_bf16 v25, v187, v7, v25
    buffer_load_dwordx4 v[184:187], v2, s[32:35], s44 offen offset:1024 nt
    s_waitcnt vmcnt(19)
    v_dot2_f32_bf16 v26, v188, v4, 0
    v_dot2_f32_bf16 v26, v189, v5, v26
    v_dot2_f32_bf16 v26, v190, v6, v26
    v_dot2_f32_bf16 v26, v191, v7, v26
    buffer_load_dwordx4 v[188:191], v2, s[32:35], s44 offen offset:2048 nt
    s_waitcnt vmcnt(19)
    v_dot2_f32_bf16 v27, v192, v4, 0
    v_dot2_f32_bf16 v27, v193, v5, v27
    v_dot2_f32_bf16 v27, v194, v6, v27
    v_dot2_f32_bf16 v27, v195, v7, v27
    buffer_load_dwordx4 v[192:195], v2, s[32:35], s44 offen offset:3072 nt
    s_nop 1
    v_add_f32_dpp v24, v24, v24 row_mirror row_mask:0xf bank_mask:0x3
    v_add_f32_dpp v25, v25, v25 row_mirror row_mask:0xf bank_mask:0x3
    v_add_f32_dpp v24, v26, v26 row_mirror row_mask:0xf bank_mask:0xc
    v_add_f32_dpp v25, v27, v27 row_mirror row_mask:0xf bank_mask:0xc
    s_nop 0
    v_add_f32_dpp v34, v24, v24 row_half_mirror row_mask:0xf bank_mask:0x5
    v_add_f32_dpp v34, v25, v25 row_half_mirror row_mask:0xf bank_mask:0xa
    s_waitcnt vmcnt(19)
    v_dot2_f32_bf16 v24, v196, v4, 0
    v_dot2_f32_bf16 v24, v197, v5, v24
    v_dot2_f32_bf16 v24, v198, v6, v24
    v_dot2_f32_bf16 v24, v199, v7, v24
    s_add_u32 s44, s37, 28672
    buffer_load_dwordx4 v[196:199], v2, s[32:35], s44 offen nt
    s_waitcnt vmcnt(19)
    v_dot2_f32_bf16 v25, v200, v4, 0
    v_dot2_f32_bf16 v25, v201, v5, v25
    v_dot2_f32_bf16 v25, v202, v6, v25
    v_dot2_f32_bf16 v25, v203, v7, v25
    buffer_load_dwordx4 v[200:203], v2, s[32:35], s44 offen offset:1024 nt
    s_waitcnt vmcnt(19)
    v_dot2_f32_bf16 v26, v204, v4, 0
    v_dot2_f32_bf16 v26, v205, v5, v26
    v_dot2_f32_bf16 v26, v206, v6, v26
    v_dot2_f32_bf16 v26, v207, v7, v26
    buffer_load_dwordx4 v[204:207], v2, s[32:35], s44 offen offset:2048 nt
    s_waitcnt vmcnt(19)
    v_dot2_f32_bf16 v27, v208, v4, 0
    v_dot2_f32_bf16 v27, v209, v5, v27
    v_dot2_f32_bf16 v27, v210, v6, v27
    v_dot2_f32_bf16 v27, v211, v7, v27
    buffer_load_dwordx4 v[208:211], v2, s[32:35], s44 offen offset:3072 nt
    s_nop 1
    v_add_f32_dpp v24, v24, v24 row_mirror row_mask:0xf bank_mask:0x3
    v_add_f32_dpp v25, v25, v25 row_mirror row_mask:0xf bank_mask:0x3
    v_add_f32_dpp v24, v26, v26 row_mirror row_mask:0xf bank_mask:0xc
    v_add_f32_dpp v25, v27, v27 row_mirror row_mask:0xf bank_mask:0xc
    s_nop 0
    v_add_f32_dpp v35, v24, v24 row_half_mirror row_mask:0xf bank_mask:0x5
    v_add_f32_dpp v35, v25, v25 row_half_mirror row_mask:0xf bank_mask:0xa
    v_cndmask_b32 v24, v33, v32, s[52:53]
    v_cndmask_b32 v25, v35, v34, s[52:53]
    v_cndmask_b32 v26, v32, v33, s[52:53]
    v_cndmask_b32 v27, v34, v35, s[52:53]
    s_nop 0
    v_add_f32_dpp v26, v24, v26 quad_perm:[1,0,3,2] row_mask:0xf bank_mask:0xf
    v_add_f32_dpp v27, v25, v27 quad_perm:[1,0,3,2] row_mask:0xf bank_mask:0xf
    v_cndmask_b32 v24, v27, v26, s[54:55]
    v_cndmask_b32 v25, v26, v27, s[54:55]
    s_nop 1
    v_add_f32_dpp v39, v24, v25 quad_perm:[2,3,0,1] row_mask:0xf bank_mask:0xf
L_kdone:
    s_waitcnt lgkmcnt(0)
    v_max3_f32 v36, v36, v38, v39
    ds_write_b64 v3, v[38:39]
    v_add_u32 v3, 512, v3
    s_lshl_b32 s49, s86, 4
    s_sub_u32 s49, s49, s43
    s_sub_u32 s44, s49, s90
    s_cmp_gt_i32 s44, 1600
    s_cselect_b32 s44, s44, 0
    s_add_u32 s43, s43, s44
    s_sub_u32 s49, s49, s44
    s_mov_b32 s90, s49
    s_cmp_eq_u32 s38, 0
    s_cselect_b32 s90, 0x100000, s90
    s_ashr_i32 s49, s49, 10
    s_max_i32 s49, s49, 0
    s_min_i32 s49, s49, 4
    s_add_u32 s43, s43, 1720
    s_add_u32 s38, s38, 1
    s_cmp_lg_u32 s38, 32
    s_cbranch_scc1 L_ktop
    v_subrev_u32 v3, 16384, v3
    v_max_f32_dpp v36, v36, v36 quad_perm:[1,0,3,2] row_mask:0xf bank_mask:0xf
    ds_read_b64 v[40:41], v3
    s_lshr_b64 s[86:87], s[86:87], 8
    v_max_f32_dpp v36, v36, v36 quad_perm:[2,3,0,1] row_mask:0xf bank_mask:0xf
    s_mov_b32 s51, s86
    s_nop 0
    v_max_f32_dpp v36, v36, v36 row_half_mirror row_mask:0xf bank_mask:0xf
    s_nop 1
    v_max_f32_dpp v36, v36, v36 row_mirror row_mask:0xf bank_mask:0xf
    s_nop 1
    v_max_f32_dpp v36, v36, v36 row_bcast:15 row_mask:0xa bank_mask:0xf
    s_nop 1
    v_max_f32_dpp v36, v36, v36 row_bcast:31 row_mask:0xc bank_mask:0xf
    s_nop 0
    v_readlane_b32 s39, v36, 63
    s_nop 1
    v_mov_b32 v36, s39
    v_mul_f32 v36, s40, v36
    s_waitcnt lgkmcnt(0)
L_vtop:
    s_add_u32 s37, s37, 65536
    v_fma_f32 v38, v40, s40, -v36
    v_fma_f32 v39, v41, s40, -v36
    v_add_u32 v3, 512, v3
    v_exp_f32 v38, v38
    v_exp_f32 v39, v39
    s_cmp_eq_u32 s38, 63
    v_cvt_pk_bf16_f32 v42, v38, v38
    v_cvt_pk_bf16_f32 v43, v39, v39
    v_and_b32 v38, 0xffff0000, v42
    v_and_b32 v39, 0xffff0000, v43
    v_add_f32 v28, v28, v38
    v_add_f32 v28, v28, v39
    s_cbranch_scc1 L_vlast
    ds_read_b64 v[40:41], v3
    s_memrealtime s[86:87]
    s_cmp_eq_u32 s49, 1
    s_cbranch_scc1 L_vb1
    s_cmp_eq_u32 s49, 0
    s_cbranch_scc1 L_vb0
    s_cmp_eq_u32 s49, 2
    s_cbranch_scc1 L_vb2
    s_cmp_eq_u32 s49, 3
    s_cbranch_scc1 L_vb3
    s_branch L_vb4
L_vb1:
    v_and_b32_dpp v16, v42, v8 row_newbcast:0 row_mask:0xf bank_mask:0xf
    v_and_b32_dpp v17, v42, v9 row_newbcast:0 row_mask:0xf bank_mask:0xf
    v_and_b32_dpp v18, v42, v10 row_newbcast:0 row_mask:0xf bank_mask:0xf
    v_and_b32_dpp v19, v42, v11 row_newbcast:0 row_mask:0xf bank_mask:0xf
    s_waitcnt vmcnt(19)
    s_nop 0
    v_mfma_f32_16x16x32_bf16 v[12:15], v[16:19], v[84:87], v[12:15]
    buffer_load_dwordx4 v[84:87], v2, s[32:35], s37 offen nt
    v_and_b32_dpp v20, v42, v8 row_newbcast:4 row_mask:0xf bank_mask:0xf
    v_and_b32_dpp v21, v42, v9 row_newbcast:4 row_mask:0xf bank_mask:0xf
    v_and_b32_dpp v22, v42, v10 row_newbcast:4 row_mask:0xf bank_mask:0xf
    v_and_b32_dpp v23, v42, v11 row_newbcast:4 row_mask:0xf bank_mask:0xf
    s_waitcnt vmcnt(19)
    s_nop 0
    v_mfma_f32_16x16x32_bf16 v[12:15], v[20:23], v[88:91], v[12:15]
    buffer_load_dwordx4 v[88:91], v2, s[32:35], s37 offen offset:1024 nt
    v_and_b32_dpp v16, v42, v8 row_newbcast:8 row_mask:0xf bank_mask:0xf
    v_and_b32_dpp v17, v42, v9 row_newbcast:8 row_mask:0xf bank_mask:0xf
    v_and_b32_dpp v18, v42, v10 row_newbcast:8 row_mask:0xf bank_mask:0xf
    v_and_b32_dpp v19, v42, v11 row_newbcast:8 row_mask:0xf bank_mask:0xf
    s_waitcnt vmcnt(19)
    s_nop 0
    v_mfma_f32_16x16x32_bf16 v[12:15], v[16:19], v[92:95], v[12:15]
    buffer_load_dwordx4 v[92:95], v2, s[32:35], s37 offen offset:2048 nt
    v_and_b32_dpp v20, v42, v8 row_newbcast:12 row_mask:0xf bank_mask:0xf
    v_and_b32_dpp v21, v42, v9 row_newbcast:12 row_mask:0xf bank_mask:0xf
    v_and_b32_dpp v22, v42, v10 row_newbcast:12 row_mask:0xf bank_mask:0xf
    v_and_b32_dpp v23, v42, v11 row_newbcast:12 row_mask:0xf bank_mask:0xf
    s_waitcnt vmcnt(19)
    s_nop 0
    v_mfma_f32_16x16x32_bf16 v[12:15], v[20:23], v[96:99], v[12:15]
    buffer_load_dwordx4 v[96:99], v2, s[32:35], s37 offen offset:3072 nt
    v_and_b32_dpp v16, v42, v8 row_newbcast:1 row_mask:0xf bank_mask:0xf
    v_and_b32_dpp v17, v42, v9 row_newbcast:1 row_mask:0xf bank_mask:0xf
    v_and_b32_dpp v18, v42, v10 row_newbcast:1 row_mask:0xf bank_mask:0xf
    v_and_b32_dpp v19, v42, v11 row_newbcast:1 row_mask:0xf bank_mask:0xf
    s_waitcnt vmcnt(19)
    s_nop 0
    v_mfma_f32_16x16x32_bf16 v[12:15], v[16:19], v[100:103], v[12:15]
    s_add_u32 s44, s37, 4096
    buffer_load_dwordx4 v[100:103], v2, s[32:35], s44 offen nt
    v_and_b32_dpp v20, v42, v8 row_newbcast:5 row_mask:0xf bank_mask:0xf
    v_and_b32_dpp v21, v42, v9 row_newbcast:5 row_mask:0xf bank_mask:0xf
    v_and_b32_dpp v22, v42, v10 row_newbcast:5 row_mask:0xf bank_mask:0xf
    v_and_b32_dpp v23, v42, v11 row_newbcast:5 row_mask:0xf bank_mask:0xf
    s_waitcnt vmcnt(19)
    s_nop 0
    v_mfma_f32_16x16x32_bf16 v[12:15], v[20:23], v[104:107], v[12:15]
    buffer_load_dwordx4 v[104:107], v2, s[32:35], s44 offen offset:1024 nt
    v_and_b32_dpp v16, v42, v8 row_newbcast:9 row_mask:0xf bank_mask:0xf
    v_and_b32_dpp v17, v42, v9 row_newbcast:9 row_mask:0xf bank_mask:0xf
    v_and_b32_dpp v18, v42, v10 row_newbcast:9 row_mask:0xf bank_mask:0xf
    v_and_b32_dpp v19, v42, v11 row_newbcast:9 row_mask:0xf bank_mask:0xf
    s_waitcnt vmcnt(19)
    s_nop 0
    v_mfma_f32_16x16x32_bf16 v[12:15], v[16:19], v[108:111], v[12:15]
    buffer_load_dwordx4 v[108:111], v2, s[32:35], s44 offen offset:2048 nt
    v_and_b32_dpp v20, v42, v8 row_newbcast:13 row_mask:0xf bank_mask:0xf
    v_and_b32_dpp v21, v42, v9 row_newbcast:13 row_mask:0xf bank_mask:0xf
    v_and_b32_dpp v22, v42, v10 row_newbcast:13 row_mask:0xf bank_mask:0xf
    v_and_b32_dpp v23, v42, v11 row_newbcast:13 row_mask:0xf bank_mask:0xf
    s_waitcnt vmcnt(19)
    s_nop 0
    v_mfma_f32_16x16x32_bf16 v[12:15], v[20:23], v[112:115], v[12:15]
    buffer_load_dwordx4 v[112:115], v2, s[32:35], s44 offen offset:3072 nt
    v_and_b32_dpp v16, v42, v8 row_newbcast:2 row_mask:0xf bank_mask:0xf
    v_and_b32_dpp v17, v42, v9 row_newbcast:2 row_mask:0xf bank_mask:0xf
    v_and_b32_dpp v18, v42, v10 row_newbcast:2 row_mask:0xf bank_mask:0xf
    v_and_b32_dpp v19, v42, v11 row_newbcast:2 row_mask:0xf bank_mask:0xf
    s_waitcnt vmcnt(19)
    s_nop 0
    v_mfma_f32_16x16x32_bf16 v[12:15], v[16:19], v[116:119], v[12:15]
    s_add_u32 s44, s37, 8192
    buffer_load_dwordx4 v[116:119], v2, s[32:35], s44 offen nt
    v_and_b32_dpp v20, v42, v8 row_newbcast:6 row_mask:0xf bank_mask:0xf
    v_and_b32_dpp v21, v42, v9 row_newbcast:6 row_mask:0xf bank_mask:0xf
    v_and_b32_dpp v22, v42, v10 row_newbcast:6 row_mask:0xf bank_mask:0xf
    v_and_b32_dpp v23, v42, v11 row_newbcast:6 row_mask:0xf bank_mask:0xf
    s_waitcnt vmcnt(19)
    s_nop 0
    v_mfma_f32_16x16x32_bf16 v[12:15], v[20:23], v[120:123], v[12:15]
    buffer_load_dwordx4 v[120:123], v2, s[32:35], s44 offen offset:1024 nt
    v_and_b32_dpp v16, v42, v8 row_newbcast:10 row_mask:0xf bank_mask:0xf
    v_and_b32_dpp v17, v42, v9 row_newbcast:10 row_mask:0xf bank_mask:0xf
    v_and_b32_dpp v18, v42, v10 row_newbcast:10 row_mask:0xf bank_mask:0xf
    v_and_b32_dpp v19, v42, v11 row_newbcast:10 row_mask:0xf bank_mask:0xf
    s_waitcnt vmcnt(19)
    s_nop 0
    v_mfma_f32_16x16x32_bf16 v[12:15], v[16:19], v[124:127], v[12:15]
    buffer_load_dwordx4 v[124:127], v2, s[32:35], s44 offen offset:2048 nt
    v_and_b32_dpp v20, v42, v8 row_newbcast:14 row_mask:0xf bank_mask:0xf
    v_and_b32_dpp v21, v42, v9 row_newbcast:14 row_mask:0xf bank_mask:0xf
    v_and_b32_dpp v22, v42, v10 row_newbcast:14 row_mask:0xf bank_mask:0xf
    v_and_b32_dpp v23, v42, v11 row_newbcast:14 row_mask:0xf bank_mask:0xf
    s_waitcnt vmcnt(19)
    s_nop 0
    v_mfma_f32_16x16x32_bf16 v[12:15], v[20:23], v[128:131], v[12:15]
    buffer_load_dwordx4 v[128:131], v2, s[32:35], s44 offen offset:3072 nt
    v_and_b32_dpp v16, v42, v8 row_newbcast:3 row_mask:0xf bank_mask:0xf
    v_and_b32_dpp v17, v42, v9 row_newbcast:3 row_mask:0xf bank_mask:0xf
    v_and_b32_dpp v18, v42, v10 row_newbcast:3 row_mask:0xf bank_mask:0xf
    v_and_b32_dpp v19, v42, v11 row_newbcast:3 row_mask:0xf bank_mask:0xf
    s_waitcnt vmcnt(19)
    s_nop 0
    v_mfma_f32_16x16x32_bf16 v[12:15], v[16:19], v[132:135], v[12:15]
    s_add_u32 s44, s37, 12288
    buffer_load_dwordx4 v[132:135], v2, s[32:35], s44 offen nt
    v_and_b32_dpp v20, v42, v8 row_newbcast:7 row_mask:0xf bank_mask:0xf
    v_and_b32_dpp v21, v42, v9 row_newbcast:7 row_mask:0xf bank_mask:0xf
    v_and_b32_dpp v22, v42, v10 row_newbcast:7 row_mask:0xf bank_mask:0xf
    v_and_b32_dpp v23, v42, v11 row_newbcast:7 row_mask:0xf bank_mask:0xf
    s_waitcnt vmcnt(19)
    s_nop 0
    v_mfma_f32_16x16x32_bf16 v[12:15], v[20:23], v[136:139], v[12:15]
    buffer_load_dwordx4 v[136:139], v2, s[32:35], s44 offen offset:1024 nt
    v_and_b32_dpp v16, v42, v8 row_newbcast:11 row_mask:0xf bank_mask:0xf
    v_and_b32_dpp v17, v42, v9 row_newbcast:11 row_mask:0xf bank_mask:0xf
    v_and_b32_dpp v18, v42, v10 row_newbcast:11 row_mask:0xf bank_mask:0xf
    v_and_b32_dpp v19, v42, v11 row_newbcast:11 row_mask:0xf bank_mask:0xf
    s_waitcnt vmcnt(19)
    s_nop 0
    v_mfma_f32_16x16x32_bf16 v[12:15], v[16:19], v[140:143], v[12:15]
    buffer_load_dwordx4 v[140:143], v2, s[32:35], s44 offen offset:2048 nt
    v_and_b32_dpp v20, v42, v8 row_newbcast:15 row_mask:0xf bank_mask:0xf
    v_and_b32_dpp v21, v42, v9 row_newbcast:15 row_mask:0xf bank_mask:0xf
    v_and_b32_dpp v22, v42, v10 row_newbcast:15 row_mask:0xf bank_mask:0xf
    v_and_b32_dpp v23, v42, v11 row_newbcast:15 row_mask:0xf bank_mask:0xf
    s_waitcnt vmcnt(19)
    s_nop 0
    v_mfma_f32_16x16x32_bf16 v[12:15], v[20:23], v[144:147], v[12:15]
    buffer_load_dwordx4 v[144:147], v2, s[32:35], s44 offen offset:3072 nt
    v_and_b32_dpp v16, v43, v8 row_newbcast:0 row_mask:0xf bank_mask:0xf
    v_and_b32_dpp v17, v43, v9 row_newbcast:0 row_mask:0xf bank_mask:0xf
    v_and_b32_dpp v18, v43, v10 row_newbcast:0 row_mask:0xf bank_mask:0xf
    v_and_b32_dpp v19, v43, v11 row_newbcast:0 row_mask:0xf bank_mask:0xf
    s_waitcnt vmcnt(19)
    s_nop 0
    v_mfma_f32_16x16x32_bf16 v[12:15], v[16:19], v[148:151], v[12:15]
    s_add_u32 s44, s37, 16384
    buffer_load_dwordx4 v[148:151], v2, s[32:35], s44 offen nt
    v_and_b32_dpp v20, v43, v8 row_newbcast:4 row_mask:0xf bank_mask:0xf
    v_and_b32_dpp v21, v43, v9 row_newbcast:4 row_mask:0xf bank_mask:0xf
    v_and_b32_dpp v22, v43, v10 row_newbcast:4 row_mask:0xf bank_mask:0xf
    v_and_b32_dpp v23, v43, v11 row_newbcast:4 row_mask:0xf bank_mask:0xf
    s_waitcnt vmcnt(19)
    s_nop 0
    v_mfma_f32_16x16x32_bf16 v[12:15], v[20:23], v[152:155], v[12:15]
    buffer_load_dwordx4 v[152:155], v2, s[32:35], s44 offen offset:1024 nt
    v_and_b32_dpp v16, v43, v8 row_newbcast:8 row_mask:0xf bank_mask:0xf
    v_and_b32_dpp v17, v43, v9 row_newbcast:8 row_mask:0xf bank_mask:0xf
    v_and_b32_dpp v18, v43, v10 row_newbcast:8 row_mask:0xf bank_mask:0xf
    v_and_b32_dpp v19, v43, v11 row_newbcast:8 row_mask:0xf bank_mask:0xf
    s_waitcnt vmcnt(19)
    s_nop 0
    v_mfma_f32_16x16x32_bf16 v[12:15], v[16:19], v[156:159], v[12:15]
    buffer_load_dwordx4 v[156:159], v2, s[32:35], s44 offen offset:2048 nt
    v_and_b32_dpp v20, v43, v8 row_newbcast:12 row_mask:0xf bank_mask:0xf
    v_and_b32_dpp v21, v43, v9 row_newbcast:12 row_mask:0xf bank_mask:0xf
    v_and_b32_dpp v22, v43, v10 row_newbcast:12 row_mask:0xf bank_mask:0xf
    v_and_b32_dpp v23, v43, v11 row_newbcast:12 row_mask:0xf bank_mask:0xf
    s_waitcnt vmcnt(19)
    s_nop 0
    v_mfma_f32_16x16x32_bf16 v[12:15], v[20:23], v[160:163], v[12:15]
    buffer_load_dwordx4 v[160:163], v2, s[32:35], s44 offen offset:3072 nt
    v_and_b32_dpp v16, v43, v8 row_newbcast:1 row_mask:0xf bank_mask:0xf
    v_and_b32_dpp v17, v43, v9 row_newbcast:1 row_mask:0xf bank_mask:0xf
    v_and_b32_dpp v18, v43, v10 row_newbcast:1 row_mask:0xf bank_mask:0xf
    v_and_b32_dpp v19, v43, v11 row_newbcast:1 row_mask:0xf bank_mask:0xf
    s_waitcnt vmcnt(19)
    s_nop 0
    v_mfma_f32_16x16x32_bf16 v[12:15], v[16:19], v[164:167], v[12:15]
    s_add_u32 s44, s37, 20480
    buffer_load_dwordx4 v[164:167], v2, s[32:35], s44 offen nt
    v_and_b32_dpp v20, v43, v8 row_newbcast:5 row_mask:0xf bank_mask:0xf
    v_and_b32_dpp v21, v43, v9 row_newbcast:5 row_mask:0xf bank_mask:0xf
    v_and_b32_dpp v22, v43, v10 row_newbcast:5 row_mask:0xf bank_mask:0xf
    v_and_b32_dpp v23, v43, v11 row_newbcast:5 row_mask:0xf bank_mask:0xf
    s_waitcnt vmcnt(19)
    s_nop 0
    v_mfma_f32_16x16x32_bf16 v[12:15], v[20:23], v[168:171], v[12:15]
    buffer_load_dwordx4 v[168:171], v2, s[32:35], s44 offen offset:1024 nt
    v_and_b32_dpp v16, v43, v8 row_newbcast:9 row_mask:0xf bank_mask:0xf
    v_and_b32_dpp v17, v43, v9 row_newbcast:9 row_mask:0xf bank_mask:0xf
    v_and_b32_dpp v18, v43, v10 row_newbcast:9 row_mask:0xf bank_mask:0xf
    v_and_b32_dpp v19, v43, v11 row_newbcast:9 row_mask:0xf bank_mask:0xf
    s_waitcnt vmcnt(19)
    s_nop 0
    v_mfma_f32_16x16x32_bf16 v[12:15], v[16:19], v[172:175], v[12:15]
    buffer_load_dwordx4 v[172:175], v2, s[32:35], s44 offen offset:2048 nt
    v_and_b32_dpp v20, v43, v8 row_newbcast:13 row_mask:0xf bank_mask:0xf
    v_and_b32_dpp v21, v43, v9 row_newbcast:13 row_mask:0xf bank_mask:0xf
    v_and_b32_dpp v22, v43, v10 row_newbcast:13 row_mask:0xf bank_mask:0xf
    v_and_b32_dpp v23, v43, v11 row_newbcast:13 row_mask:0xf bank_mask:0xf
    s_waitcnt vmcnt(19)
    s_nop 0
    v_mfma_f32_16x16x32_bf16 v[12:15], v[20:23], v[176:179], v[12:15]
    buffer_load_dwordx4 v[176:179], v2, s[32:35], s44 offen offset:3072 nt
    v_and_b32_dpp v16, v43, v8 row_newbcast:2 row_mask:0xf bank_mask:0xf
    v_and_b32_dpp v17, v43, v9 row_newbcast:2 row_mask:0xf bank_mask:0xf
    v_and_b32_dpp v18, v43, v10 row_newbcast:2 row_mask:0xf bank_mask:0xf
    v_and_b32_dpp v19, v43, v11 row_newbcast:2 row_mask:0xf bank_mask:0xf
    s_waitcnt vmcnt(19)
    s_nop 0
    v_mfma_f32_16x16x32_bf16 v[12:15], v[16:19], v[180:183], v[12:15]
    s_add_u32 s44, s37, 24576
    buffer_load_dwordx4 v[180:183], v2, s[32:35], s44 offen nt
    v_and_b32_dpp v20, v43, v8 row_newbcast:6 row_mask:0xf bank_mask:0xf
    v_and_b32_dpp v21, v43, v9 row_newbcast:6 row_mask:0xf bank_mask:0xf
    v_and_b32_dpp v22, v43, v10 row_newbcast:6 row_mask:0xf bank_mask:0xf
    v_and_b32_dpp v23, v43, v11 row_newbcast:6 row_mask:0xf bank_mask:0xf
    s_waitcnt vmcnt(19)
    s_nop 0
    v_mfma_f32_16x16x32_bf16 v[12:15], v[20:23], v[184:187], v[12:15]
    buffer_load_dwordx4 v[184:187], v2, s[32:35], s44 offen offset:1024 nt
    v_and_b32_dpp v16, v43, v8 row_newbcast:10 row_mask:0xf bank_mask:0xf
    v_and_b32_dpp v17, v43, v9 row_newbcast:10 row_mask:0xf bank_mask:0xf
    v_and_b32_dpp v18, v43, v10 row_newbcast:10 row_mask:0xf bank_mask:0xf
    v_and_b32_dpp v19, v43, v11 row_newbcast:10 row_mask:0xf bank_mask:0xf
    s_waitcnt vmcnt(19)
    s_nop 0
    v_mfma_f32_16x16x32_bf16 v[12:15], v[16:19], v[188:191], v[12:15]
    buffer_load_dwordx4 v[188:191], v2, s[32:35], s44 offen offset:2048 nt
    v_and_b32_dpp v20, v43, v8 row_newbcast:14 row_mask:0xf bank_mask:0xf
    v_and_b32_dpp v21, v43, v9 row_newbcast:14 row_mask:0xf bank_mask:0xf
    v_and_b32_dpp v22, v43, v10 row_newbcast:14 row_mask:0xf bank_mask:0xf
    v_and_b32_dpp v23, v43, v11 row_newbcast:14 row_mask:0xf bank_mask:0xf
    s_waitcnt vmcnt(19)
    s_nop 0
    v_mfma_f32_16x16x32_bf16 v[12:15], v[20:23], v[192:195], v[12:15]
    buffer_load_dwordx4 v[192:195], v2, s[32:35], s44 offen offset:3072 nt
    v_and_b32_dpp v16, v43, v8 row_newbcast:3 row_mask:0xf bank_mask:0xf
    v_and_b32_dpp v17, v43, v9 row_newbcast:3 row_mask:0xf bank_mask:0xf
    v_and_b32_dpp v18, v43, v10 row_newbcast:3 row_mask:0xf bank_mask:0xf
    v_and_b32_dpp v19, v43, v11 row_newbcast:3 row_mask:0xf bank_mask:0xf
    s_waitcnt vmcnt(19)
    s_nop 0
    v_mfma_f32_16x16x32_bf16 v[12:15], v[16:19], v[196:199], v[12:15]
    s_add_u32 s44, s37, 28672
    buffer_load_dwordx4 v[196:199], v2, s[32:35], s44 offen nt
    v_and_b32_dpp v20, v43, v8 row_newbcast:7 row_mask:0xf bank_mask:0xf
    v_and_b32_dpp v21, v43, v9 row_newbcast:7 row_mask:0xf bank_mask:0xf
    v_and_b32_dpp v22, v43, v10 row_newbcast:7 row_mask:0xf bank_mask:0xf
    v_and_b32_dpp v23, v43, v11 row_newbcast:7 row_mask:0xf bank_mask:0xf
    s_waitcnt vmcnt(19)
    s_nop 0
    v_mfma_f32_16x16x32_bf16 v[12:15], v[20:23], v[200:203], v[12:15]
    buffer_load_dwordx4 v[200:203], v2, s[32:35], s44 offen offset:1024 nt
    v_and_b32_dpp v16, v43, v8 row_newbcast:11 row_mask:0xf bank_mask:0xf
    v_and_b32_dpp v17, v43, v9 row_newbcast:11 row_mask:0xf bank_mask:0xf
    v_and_b32_dpp v18, v43, v10 row_newbcast:11 row_mask:0xf bank_mask:0xf
    v_and_b32_dpp v19, v43, v11 row_newbcast:11 row_mask:0xf bank_mask:0xf
    s_waitcnt vmcnt(19)
    s_nop 0
    v_mfma_f32_16x16x32_bf16 v[12:15], v[16:19], v[204:207], v[12:15]
    buffer_load_dwordx4 v[204:207], v2, s[32:35], s44 offen offset:2048 nt
    v_and_b32_dpp v20, v43, v8 row_newbcast:15 row_mask:0xf bank_mask:0xf
    v_and_b32_dpp v21, v43, v9 row_newbcast:15 row_mask:0xf bank_mask:0xf
    v_and_b32_dpp v22, v43, v10 row_newbcast:15 row_mask:0xf bank_mask:0xf
    v_and_b32_dpp v23, v43, v11 row_newbcast:15 row_mask:0xf bank_mask:0xf
    s_waitcnt vmcnt(19)
    s_nop 0
    v_mfma_f32_16x16x32_bf16 v[12:15], v[20:23], v[208:211], v[12:15]
    buffer_load_dwordx4 v[208:211], v2, s[32:35], s44 offen offset:3072 nt
L_vdone:
    s_waitcnt lgkmcnt(0)
    s_lshl_b32 s49, s86, 4
    s_sub_u32 s49, s49, s43
    s_sub_u32 s44, s49, s90
    s_cmp_gt_i32 s44, 1600
    s_cselect_b32 s44, s44, 0
    s_add_u32 s43, s43, s44
    s_sub_u32 s49, s49, s44
    s_mov_b32 s90, s49
    s_ashr_i32 s49, s49, 10
    s_max_i32 s49, s49, 0
    s_min_i32 s49, s49, 4
    s_add_u32 s43, s43, 1720
    s_add_u32 s38, s38, 1
    s_cmp_lg_u32 s38, 60
    s_cbranch_scc1 L_vtop
    s_getpc_b64 s[88:89]
L_pcb:
    s_add_u32 s88, s88, L_vlast-L_pcb
    s_addc_u32 s89, s89, 0
    v_lshlrev_b32 v29, 7, v0
    v_min_u32 v29, L_end-L_vlast-4, v29
    global_load_dword v47, v29, s[88:89]
    s_branch L_vtop
L_kb0:
    s_waitcnt vmcnt(18)
    v_dot2_f32_bf16 v24, v84, v4, 0
    v_dot2_f32_bf16 v24, v85, v5, v24
    v_dot2_f32_bf16 v24, v86, v6, v24
    v_dot2_f32_bf16 v24, v87, v7, v24
    buffer_load_dwordx4 v[84:87], v2, s[32:35], s37 offen nt
    s_waitcnt vmcnt(18)
    v_dot2_f32_bf16 v25, v88, v4, 0
    v_dot2_f32_bf16 v25, v89, v5, v25
    v_dot2_f32_bf16 v25, v90, v6, v25
    v_dot2_f32_bf16 v25, v91, v7, v25
    buffer_load_dwordx4 v[88:91], v2, s[32:35], s37 offen offset:1024 nt
    s_waitcnt vmcnt(18)
    v_dot2_f32_bf16 v26, v92, v4, 0
    v_dot2_f32_bf16 v26, v93, v5, v26
    v_dot2_f32_bf16 v26, v94, v6, v26
    v_dot2_f32_bf16 v26, v95, v7, v26
    buffer_load_dwordx4 v[92:95], v2, s[32:35], s37 offen offset:2048 nt
    s_waitcnt vmcnt(18)
    v_dot2_f32_bf16 v27, v96, v4, 0
    v_dot2_f32_bf16 v27, v97, v5, v27
    v_dot2_f32_bf16 v27, v98, v6, v27
    v_dot2_f32_bf16 v27, v99, v7, v27
    buffer_load_dwordx4 v[96:99], v2, s[32:35], s37 offen offset:3072 nt
    s_nop 1
    v_add_f32_dpp v24, v24, v24 row_mirror row_mask:0xf bank_mask:0x3
    v_add_f32_dpp v25, v25, v25 row_mirror row_mask:0xf bank_mask:0x3
    v_add_f32_dpp v24, v26, v26 row_mirror row_mask:0xf bank_mask:0xc
    v_add_f32_dpp v25, v27, v27 row_mirror row_mask:0xf bank_mask:0xc
    s_nop 0
    v_add_f32_dpp v32, v24, v24 row_half_mirror row_mask:0xf bank_mask:0x5
    v_add_f32_dpp v32, v25, v25 row_half_mirror row_mask:0xf bank_mask:0xa
    s_waitcnt vmcnt(18)
    v_dot2_f32_bf16 v24, v100, v4, 0
    v_dot2_f32_bf16 v24, v101, v5, v24
    v_dot2_f32_bf16 v24, v102, v6, v24
    v_dot2_f32_bf16 v24, v103, v7, v24
    s_add_u32 s44, s37, 4096
    buffer_load_dwordx4 v[100:103], v2, s[32:35], s44 offen nt
    s_waitcnt vmcnt(18)
    v_dot2_f32_bf16 v25, v104, v4, 0
    v_dot2_f32_bf16 v25, v105, v5, v25
    v_dot2_f32_bf16 v25, v106, v6, v25
    v_dot2_f32_bf16 v25, v107, v7, v25
    buffer_load_dwordx4 v[104:107], v2, s[32:35], s44 offen offset:1024 nt
    s_waitcnt vmcnt(18)
    v_dot2_f32_bf16 v26, v108, v4, 0
    v_dot2_f32_bf16 v26, v109, v5, v26
    v_dot2_f32_bf16 v26, v110, v6, v26
    v_dot2_f32_bf16 v26, v111, v7, v26
    buffer_load_dwordx4 v[108:111], v2, s[32:35], s44 offen offset:2048 nt
    s_waitcnt vmcnt(18)
    v_dot2_f32_bf16 v27, v112, v4, 0
    v_dot2_f32_bf16 v27, v113, v5, v27
    v_dot2_f32_bf16 v27, v114, v6, v27
    v_dot2_f32_bf16 v27, v115, v7, v27
    buffer_load_dwordx4 v[112:115], v2, s[32:35], s44 offen offset:3072 nt
    s_nop 1
    v_add_f32_dpp v24, v24, v24 row_mirror row_mask:0xf bank_mask:0x3
    v_add_f32_dpp v25, v25, v25 row_mirror row_mask:0xf bank_mask:0x3
    v_add_f32_dpp v24, v26, v26 row_mirror row_mask:0xf bank_mask:0xc
    v_add_f32_dpp v25, v27, v27 row_mirror row_mask:0xf bank_mask:0xc
    s_nop 0
    v_add_f32_dpp v33, v24, v24 row_half_mirror row_mask:0xf bank_mask:0x5
    v_add_f32_dpp v33, v25, v25 row_half_mirror row_mask:0xf bank_mask:0xa
    s_waitcnt vmcnt(18)
    v_dot2_f32_bf16 v24, v116, v4, 0
    v_dot2_f32_bf16 v24, v117, v5, v24
    v_dot2_f32_bf16 v24, v118, v6, v24
    v_dot2_f32_bf16 v24, v119, v7, v24
    s_add_u32 s44, s37, 8192
    buffer_load_dwordx4 v[116:119], v2, s[32:35], s44 offen nt
    s_waitcnt vmcnt(18)
    v_dot2_f32_bf16 v25, v120, v4, 0
    v_dot2_f32_bf16 v25, v121, v5, v25
    v_dot2_f32_bf16 v25, v122, v6, v25
    v_dot2_f32_bf16 v25, v123, v7, v25
    buffer_load_dwordx4 v[120:123], v2, s[32:35], s44 offen offset:1024 nt
    s_waitcnt vmcnt(18)
    v_dot2_f32_bf16 v26, v124, v4, 0
    v_dot2_f32_bf16 v26, v125, v5, v26
    v_dot2_f32_bf16 v26, v126, v6, v26
    v_dot2_f32_bf16 v26, v127, v7, v26
    buffer_load_dwordx4 v[124:127], v2, s[32:35], s44 offen offset:2048 nt
    s_waitcnt vmcnt(18)
    v_dot2_f32_bf16 v27, v128, v4, 0
    v_dot2_f32_bf16 v27, v129, v5, v27
    v_dot2_f32_bf16 v27, v130, v6, v27
    v_dot2_f32_bf16 v27, v131, v7, v27
    buffer_load_dwordx4 v[128:131], v2, s[32:35], s44 offen offset:3072 nt
    s_nop 1
    v_add_f32_dpp v24, v24, v24 row_mirror row_mask:0xf bank_mask:0x3
    v_add_f32_dpp v25, v25, v25 row_mirror row_mask:0xf bank_mask:0x3
    v_add_f32_dpp v24, v26, v26 row_mirror row_mask:0xf bank_mask:0xc
    v_add_f32_dpp v25, v27, v27 row_mirror row_mask:0xf bank_mask:0xc
    s_nop 0
    v_add_f32_dpp v34, v24, v24 row_half_mirror row_mask:0xf bank_mask:0x5
    v_add_f32_dpp v34, v25, v25 row_half_mirror row_mask:0xf bank_mask:0xa
    s_waitcnt vmcnt(18)
    v_dot2_f32_bf16 v24, v132, v4, 0
    v_dot2_f32_bf16 v24, v133, v5, v24
    v_dot2_f32_bf16 v24, v134, v6, v24
    v_dot2_f32_bf16 v24, v135, v7, v24
    s_add_u32 s44, s37, 12288
    buffer_load_dwordx4 v[132:135], v2, s[32:35], s44 offen nt
    s_waitcnt vmcnt(18)
    v_dot2_f32_bf16 v25, v136, v4, 0
    v_dot2_f32_bf16 v25, v137, v5, v25
    v_dot2_f32_bf16 v25, v138, v6, v25
    v_dot2_f32_bf16 v25, v139, v7, v25
    buffer_load_dwordx4 v[136:139], v2, s[32:35], s44 offen offset:1024 nt
    s_waitcnt vmcnt(18)
    v_dot2_f32_bf16 v26, v140, v4, 0
    v_dot2_f32_bf16 v26, v141, v5, v26
    v_dot2_f32_bf16 v26, v142, v6, v26
    v_dot2_f32_bf16 v26, v143, v7, v26
    buffer_load_dwordx4 v[140:143], v2, s[32:35], s44 offen offset:2048 nt
    s_waitcnt vmcnt(18)
    v_dot2_f32_bf16 v27, v144, v4, 0
    v_dot2_f32_bf16 v27, v145, v5, v27
    v_dot2_f32_bf16 v27, v146, v6, v27
    v_dot2_f32_bf16 v27, v147, v7, v27
    buffer_load_dwordx4 v[144:147], v2, s[32:35], s44 offen offset:3072 nt
    s_nop 1
    v_add_f32_dpp v24, v24, v24 row_mirror row_mask:0xf bank_mask:0x3
    v_add_f32_dpp v25, v25, v25 row_mirror row_mask:0xf bank_mask:0x3
    v_add_f32_dpp v24, v26, v26 row_mirror row_mask:0xf bank_mask:0xc
    v_add_f32_dpp v25, v27, v27 row_mirror row_mask:0xf bank_mask:0xc
    s_nop 0
    v_add_f32_dpp v35, v24, v24 row_half_mirror row_mask:0xf bank_mask:0x5
    v_add_f32_dpp v35, v25, v25 row_half_mirror row_mask:0xf bank_mask:0xa
    v_cndmask_b32 v24, v33, v32, s[52:53]
    v_cndmask_b32 v25, v35, v34, s[52:53]
    v_cndmask_b32 v26, v32, v33, s[52:53]
    v_cndmask_b32 v27, v34, v35, s[52:53]
    s_nop 0
    v_add_f32_dpp v26, v24, v26 quad_perm:[1,0,3,2] row_mask:0xf bank_mask:0xf
    v_add_f32_dpp v27, v25, v27 quad_perm:[1,0,3,2] row_mask:0xf bank_mask:0xf
    v_cndmask_b32 v24, v27, v26, s[54:55]
    v_cndmask_b32 v25, v26, v27, s[54:55]
    s_nop 1
    v_add_f32_dpp v38, v24, v25 quad_perm:[2,3,0,1] row_mask:0xf bank_mask:0xf
    s_waitcnt vmcnt(18)
    v_dot2_f32_bf16 v24, v148, v4, 0
    v_dot2_f32_bf16 v24, v149, v5, v24
    v_dot2_f32_bf16 v24, v150, v6, v24
    v_dot2_f32_bf16 v24, v151, v7, v24
    s_add_u32 s44, s37, 16384
    buffer_load_dwordx4 v[148:151], v2, s[32:35], s44 offen nt
    s_waitcnt vmcnt(18)
    v_dot2_f32_bf16 v25, v152, v4, 0
    v_dot2_f32_bf16 v25, v153, v5, v25
    v_dot2_f32_bf16 v25, v154, v6, v25
    v_dot2_f32_bf16 v25, v155, v7, v25
    buffer_load_dwordx4 v[152:155], v2, s[32:35], s44 offen offset:1024 nt
    s_waitcnt vmcnt(18)
    v_dot2_f32_bf16 v26, v156, v4, 0
    v_dot2_f32_bf16 v26, v157, v5, v26
    v_dot2_f32_bf16 v26, v158, v6, v26
    v_dot2_f32_bf16 v26, v159, v7, v26
    buffer_load_dwordx4 v[156:159], v2, s[32:35], s44 offen offset:2048 nt
    s_waitcnt vmcnt(18)
    v_dot2_f32_bf16 v27, v160, v4, 0
    v_dot2_f32_bf16 v27, v161, v5, v27
    v_dot2_f32_bf16 v27, v162, v6, v27
    v_dot2_f32_bf16 v27, v163, v7, v27
    buffer_load_dwordx4 v[160:163], v2, s[32:35], s44 offen offset:3072 nt
    s_nop 1
    v_add_f32_dpp v24, v24, v24 row_mirror row_mask:0xf bank_mask:0x3
    v_add_f32_dpp v25, v25, v25 row_mirror row_mask:0xf bank_mask:0x3
    v_add_f32_dpp v24, v26, v26 row_mirror row_mask:0xf bank_mask:0xc
    v_add_f32_dpp v25, v27, v27 row_mirror row_mask:0xf bank_mask:0xc
    s_nop 0
    v_add_f32_dpp v32, v24, v24 row_half_mirror row_mask:0xf bank_mask:0x5
    v_add_f32_dpp v32, v25, v25 row_half_mirror row_mask:0xf bank_mask:0xa
    s_waitcnt vmcnt(18)
    v_dot2_f32_bf16 v24, v164, v4, 0
    v_dot2_f32_bf16 v24, v165, v5, v24
    v_dot2_f32_bf16 v24, v166, v6, v24
    v_dot2_f32_bf16 v24, v167, v7, v24
    s_add_u32 s44, s37, 20480
    buffer_load_dwordx4 v[164:167], v2, s[32:35], s44 offen nt
    s_waitcnt vmcnt(18)
    v_dot2_f32_bf16 v25, v168, v4, 0
    v_dot2_f32_bf16 v25, v169, v5, v25
    v_dot2_f32_bf16 v25, v170, v6, v25
    v_dot2_f32_bf16 v25, v171, v7, v25
    buffer_load_dwordx4 v[168:171], v2, s[32:35], s44 offen offset:1024 nt
    s_waitcnt vmcnt(18)
    v_dot2_f32_bf16 v26, v172, v4, 0
    v_dot2_f32_bf16 v26, v173, v5, v26
    v_dot2_f32_bf16 v26, v174, v6, v26
    v_dot2_f32_bf16 v26, v175, v7, v26
    buffer_load_dwordx4 v[172:175], v2, s[32:35], s44 offen offset:2048 nt
    s_waitcnt vmcnt(18)
    v_dot2_f32_bf16 v27, v176, v4, 0
    v_dot2_f32_bf16 v27, v177, v5, v27
    v_dot2_f32_bf16 v27, v178, v6, v27
    v_dot2_f32_bf16 v27, v179, v7, v27
    buffer_load_dwordx4 v[176:179], v2, s[32:35], s44 offen offset:3072 nt
    s_nop 1
    v_add_f32_dpp v24, v24, v24 row_mirror row_mask:0xf bank_mask:0x3
    v_add_f32_dpp v25, v25, v25 row_mirror row_mask:0xf bank_mask:0x3
    v_add_f32_dpp v24, v26, v26 row_mirror row_mask:0xf bank_mask:0xc
    v_add_f32_dpp v25, v27, v27 row_mirror row_mask:0xf bank_mask:0xc
    s_nop 0
    v_add_f32_dpp v33, v24, v24 row_half_mirror row_mask:0xf bank_mask:0x5
    v_add_f32_dpp v33, v25, v25 row_half_mirror row_mask:0xf bank_mask:0xa
    s_waitcnt vmcnt(18)
    v_dot2_f32_bf16 v24, v180, v4, 0
    v_dot2_f32_bf16 v24, v181, v5, v24
    v_dot2_f32_bf16 v24, v182, v6, v24
    v_dot2_f32_bf16 v24, v183, v7, v24
    s_add_u32 s44, s37, 24576
    buffer_load_dwordx4 v[180:183], v2, s[32:35], s44 offen nt
    s_waitcnt vmcnt(18)
    v_dot2_f32_bf16 v25, v184, v4, 0
    v_dot2_f32_bf16 v25, v185, v5, v25
    v_dot2_f32_bf16 v25, v186, v6, v25
    v_dot2_f32_bf16 v25, v187, v7, v25
    buffer_load_dwordx4 v[184:187], v2, s[32:35], s44 offen offset:1024 nt
    s_waitcnt vmcnt(18)
    v_dot2_f32_bf16 v26, v188, v4, 0
    v_dot2_f32_bf16 v26, v189, v5, v26
    v_dot2_f32_bf16 v26, v190, v6, v26
    v_dot2_f32_bf16 v26, v191, v7, v26
    buffer_load_dwordx4 v[188:191], v2, s[32:35], s44 offen offset:2048 nt
    s_waitcnt vmcnt(18)
    v_dot2_f32_bf16 v27, v192, v4, 0
    v_dot2_f32_bf16 v27, v193, v5, v27
    v_dot2_f32_bf16 v27, v194, v6, v27
    v_dot2_f32_bf16 v27, v195, v7, v27
    buffer_load_dwordx4 v[192:195], v2, s[32:35], s44 offen offset:3072 nt
    s_nop 1
    v_add_f32_dpp v24, v24, v24 row_mirror row_mask:0xf bank_mask:0x3
    v_add_f32_dpp v25, v25, v25 row_mirror row_mask:0xf bank_mask:0x3
    v_add_f32_dpp v24, v26, v26 row_mirror row_mask:0xf bank_mask:0xc
    v_add_f32_dpp v25, v27, v27 row_mirror row_mask:0xf bank_mask:0xc
    s_nop 0
    v_add_f32_dpp v34, v24, v24 row_half_mirror row_mask:0xf bank_mask:0x5
    v_add_f32_dpp v34, v25, v25 row_half_mirror row_mask:0xf bank_mask:0xa
    s_waitcnt vmcnt(18)
    v_dot2_f32_bf16 v24, v196, v4, 0
    v_dot2_f32_bf16 v24, v197, v5, v24
    v_dot2_f32_bf16 v24, v198, v6, v24
    v_dot2_f32_bf16 v24, v199, v7, v24
    s_add_u32 s44, s37, 28672
    buffer_load_dwordx4 v[196:199], v2, s[32:35], s44 offen nt
    s_waitcnt vmcnt(18)
    v_dot2_f32_bf16 v25, v200, v4, 0
    v_dot2_f32_bf16 v25, v201, v5, v25
    v_dot2_f32_bf16 v25, v202, v6, v25
    v_dot2_f32_bf16 v25, v203, v7, v25
    buffer_load_dwordx4 v[200:203], v2, s[32:35], s44 offen offset:1024 nt
    s_waitcnt vmcnt(18)
    v_dot2_f32_bf16 v26, v204, v4, 0
    v_dot2_f32_bf16 v26, v205, v5, v26
    v_dot2_f32_bf16 v26, v206, v6, v26
    v_dot2_f32_bf16 v26, v207, v7, v26
    buffer_load_dwordx4 v[204:207], v2, s[32:35], s44 offen offset:2048 nt
    s_waitcnt vmcnt(18)
    v_dot2_f32_bf16 v27, v208, v4, 0
    v_dot2_f32_bf16 v27, v209, v5, v27
    v_dot2_f32_bf16 v27, v210, v6, v27
    v_dot2_f32_bf16 v27, v211, v7, v27
    buffer_load_dwordx4 v[208:211], v2, s[32:35], s44 offen offset:3072 nt
    s_nop 1
    v_add_f32_dpp v24, v24, v24 row_mirror row_mask:0xf bank_mask:0x3
    v_add_f32_dpp v25, v25, v25 row_mirror row_mask:0xf bank_mask:0x3
    v_add_f32_dpp v24, v26, v26 row_mirror row_mask:0xf bank_mask:0xc
    v_add_f32_dpp v25, v27, v27 row_mirror row_mask:0xf bank_mask:0xc
    s_nop 0
    v_add_f32_dpp v35, v24, v24 row_half_mirror row_mask:0xf bank_mask:0x5
    v_add_f32_dpp v35, v25, v25 row_half_mirror row_mask:0xf bank_mask:0xa
    v_cndmask_b32 v24, v33, v32, s[52:53]
    v_cndmask_b32 v25, v35, v34, s[52:53]
    v_cndmask_b32 v26, v32, v33, s[52:53]
    v_cndmask_b32 v27, v34, v35, s[52:53]
    s_nop 0
    v_add_f32_dpp v26, v24, v26 quad_perm:[1,0,3,2] row_mask:0xf bank_mask:0xf
    v_add_f32_dpp v27, v25, v27 quad_perm:[1,0,3,2] row_mask:0xf bank_mask:0xf
    v_cndmask_b32 v24, v27, v26, s[54:55]
    v_cndmask_b32 v25, v26, v27, s[54:55]
    s_nop 1
    v_add_f32_dpp v39, v24, v25 quad_perm:[2,3,0,1] row_mask:0xf bank_mask:0xf
    s_branch L_kdone
L_kb2:
    s_waitcnt vmcnt(20)
    v_dot2_f32_bf16 v24, v84, v4, 0
    v_dot2_f32_bf16 v24, v85, v5, v24
    v_dot2_f32_bf16 v24, v86, v6, v24
    v_dot2_f32_bf16 v24, v87, v7, v24
    buffer_load_dwordx4 v[84:87], v2, s[32:35], s37 offen nt
    s_waitcnt vmcnt(20)
    v_dot2_f32_bf16 v25, v88, v4, 0
    v_dot2_f32_bf16 v25, v89, v5, v25
    v_dot2_f32_bf16 v25, v90, v6, v25
    v_dot2_f32_bf16 v25, v91, v7, v25
    buffer_load_dwordx4 v[88:91], v2, s[32:35], s37 offen offset:1024 nt
    s_waitcnt vmcnt(20)
    v_dot2_f32_bf16 v26, v92, v4, 0
    v_dot2_f32_bf16 v26, v93, v5, v26
    v_dot2_f32_bf16 v26, v94, v6, v26
    v_dot2_f32_bf16 v26, v95, v7, v26
    buffer_load_dwordx4 v[92:95], v2, s[32:35], s37 offen offset:2048 nt
    s_waitcnt vmcnt(20)
    v_dot2_f32_bf16 v27, v96, v4, 0
    v_dot2_f32_bf16 v27, v97, v5, v27
    v_dot2_f32_bf16 v27, v98, v6, v27
    v_dot2_f32_bf16 v27, v99, v7, v27
    buffer_load_dwordx4 v[96:99], v2, s[32:35], s37 offen offset:3072 nt
    s_nop 1
    v_add_f32_dpp v24, v24, v24 row_mirror row_mask:0xf bank_mask:0x3
    v_add_f32_dpp v25, v25, v25 row_mirror row_mask:0xf bank_mask:0x3
    v_add_f32_dpp v24, v26, v26 row_mirror row_mask:0xf bank_mask:0xc
    v_add_f32_dpp v25, v27, v27 row_mirror row_mask:0xf bank_mask:0xc
    s_nop 0
    v_add_f32_dpp v32, v24, v24 row_half_mirror row_mask:0xf bank_mask:0x5
    v_add_f32_dpp v32, v25, v25 row_half_mirror row_mask:0xf bank_mask:0xa
    s_waitcnt vmcnt(20)
    v_dot2_f32_bf16 v24, v100, v4, 0
    v_dot2_f32_bf16 v24, v101, v5, v24
    v_dot2_f32_bf16 v24, v102, v6, v24
    v_dot2_f32_bf16 v24, v103, v7, v24
    s_add_u32 s44, s37, 4096
    buffer_load_dwordx4 v[100:103], v2, s[32:35], s44 offen nt
    s_waitcnt vmcnt(20)
    v_dot2_f32_bf16 v25, v104, v4, 0
    v_dot2_f32_bf16 v25, v105, v5, v25
    v_dot2_f32_bf16 v25, v106, v6, v25
    v_dot2_f32_bf16 v25, v107, v7, v25
    buffer_load_dwordx4 v[104:107], v2, s[32:35], s44 offen offset:1024 nt
    s_waitcnt vmcnt(20)
    v_dot2_f32_bf16 v26, v108, v4, 0
    v_dot2_f32_bf16 v26, v109, v5, v26
    v_dot2_f32_bf16 v26, v110, v6, v26
    v_dot2_f32_bf16 v26, v111, v7, v26
    buffer_load_dwordx4 v[108:111], v2, s[32:35], s44 offen offset:2048 nt
    s_waitcnt vmcnt(20)
    v_dot2_f32_bf16 v27, v112, v4, 0
    v_dot2_f32_bf16 v27, v113, v5, v27
    v_dot2_f32_bf16 v27, v114, v6, v27
    v_dot2_f32_bf16 v27, v115, v7, v27
    buffer_load_dwordx4 v[112:115], v2, s[32:35], s44 offen offset:3072 nt
    s_nop 1
    v_add_f32_dpp v24, v24, v24 row_mirror row_mask:0xf bank_mask:0x3
    v_add_f32_dpp v25, v25, v25 row_mirror row_mask:0xf bank_mask:0x3
    v_add_f32_dpp v24, v26, v26 row_mirror row_mask:0xf bank_mask:0xc
    v_add_f32_dpp v25, v27, v27 row_mirror row_mask:0xf bank_mask:0xc
    s_nop 0
    v_add_f32_dpp v33, v24, v24 row_half_mirror row_mask:0xf bank_mask:0x5
    v_add_f32_dpp v33, v25, v25 row_half_mirror row_mask:0xf bank_mask:0xa
    s_waitcnt vmcnt(20)
    v_dot2_f32_bf16 v24, v116, v4, 0
    v_dot2_f32_bf16 v24, v117, v5, v24
    v_dot2_f32_bf16 v24, v118, v6, v24
    v_dot2_f32_bf16 v24, v119, v7, v24
    s_add_u32 s44, s37, 8192
    buffer_load_dwordx4 v[116:119], v2, s[32:35], s44 offen nt
    s_waitcnt vmcnt(20)
    v_dot2_f32_bf16 v25, v120, v4, 0
    v_dot2_f32_bf16 v25, v121, v5, v25
    v_dot2_f32_bf16 v25, v122, v6, v25
    v_dot2_f32_bf16 v25, v123, v7, v25
    buffer_load_dwordx4 v[120:123], v2, s[32:35], s44 offen offset:1024 nt
    s_waitcnt vmcnt(20)
    v_dot2_f32_bf16 v26, v124, v4, 0
    v_dot2_f32_bf16 v26, v125, v5, v26
    v_dot2_f32_bf16 v26, v126, v6, v26
    v_dot2_f32_bf16 v26, v127, v7, v26
    buffer_load_dwordx4 v[124:127], v2, s[32:35], s44 offen offset:2048 nt
    s_waitcnt vmcnt(20)
    v_dot2_f32_bf16 v27, v128, v4, 0
    v_dot2_f32_bf16 v27, v129, v5, v27
    v_dot2_f32_bf16 v27, v130, v6, v27
    v_dot2_f32_bf16 v27, v131, v7, v27
    buffer_load_dwordx4 v[128:131], v2, s[32:35], s44 offen offset:3072 nt
    s_nop 1
    v_add_f32_dpp v24, v24, v24 row_mirror row_mask:0xf bank_mask:0x3
    v_add_f32_dpp v25, v25, v25 row_mirror row_mask:0xf bank_mask:0x3
    v_add_f32_dpp v24, v26, v26 row_mirror row_mask:0xf bank_mask:0xc
    v_add_f32_dpp v25, v27, v27 row_mirror row_mask:0xf bank_mask:0xc
    s_nop 0
    v_add_f32_dpp v34, v24, v24 row_half_mirror row_mask:0xf bank_mask:0x5
    v_add_f32_dpp v34, v25, v25 row_half_mirror row_mask:0xf bank_mask:0xa
    s_waitcnt vmcnt(20)
    v_dot2_f32_bf16 v24, v132, v4, 0
    v_dot2_f32_bf16 v24, v133, v5, v24
    v_dot2_f32_bf16 v24, v134, v6, v24
    v_dot2_f32_bf16 v24, v135, v7, v24
    s_add_u32 s44, s37, 12288
    buffer_load_dwordx4 v[132:135], v2, s[32:35], s44 offen nt
    s_waitcnt vmcnt(20)
    v_dot2_f32_bf16 v25, v136, v4, 0
    v_dot2_f32_bf16 v25, v137, v5, v25
    v_dot2_f32_bf16 v25, v138, v6, v25
    v_dot2_f32_bf16 v25, v139, v7, v25
    buffer_load_dwordx4 v[136:139], v2, s[32:35], s44 offen offset:1024 nt
    s_waitcnt vmcnt(20)
    v_dot2_f32_bf16 v26, v140, v4, 0
    v_dot2_f32_bf16 v26, v141, v5, v26
    v_dot2_f32_bf16 v26, v142, v6, v26
    v_dot2_f32_bf16 v26, v143, v7, v26
    buffer_load_dwordx4 v[140:143], v2, s[32:35], s44 offen offset:2048 nt
    s_waitcnt vmcnt(20)
    v_dot2_f32_bf16 v27, v144, v4, 0
    v_dot2_f32_bf16 v27, v145, v5, v27
    v_dot2_f32_bf16 v27, v146, v6, v27
    v_dot2_f32_bf16 v27, v147, v7, v27
    buffer_load_dwordx4 v[144:147], v2, s[32:35], s44 offen offset:3072 nt
    s_nop 1
    v_add_f32_dpp v24, v24, v24 row_mirror row_mask:0xf bank_mask:0x3
    v_add_f32_dpp v25, v25, v25 row_mirror row_mask:0xf bank_mask:0x3
    v_add_f32_dpp v24, v26, v26 row_mirror row_mask:0xf bank_mask:0xc
    v_add_f32_dpp v25, v27, v27 row_mirror row_mask:0xf bank_mask:0xc
    s_nop 0
    v_add_f32_dpp v35, v24, v24 row_half_mirror row_mask:0xf bank_mask:0x5
    v_add_f32_dpp v35, v25, v25 row_half_mirror row_mask:0xf bank_mask:0xa
    v_cndmask_b32 v24, v33, v32, s[52:53]
    v_cndmask_b32 v25, v35, v34, s[52:53]
    v_cndmask_b32 v26, v32, v33, s[52:53]
    v_cndmask_b32 v27, v34, v35, s[52:53]
    s_nop 0
    v_add_f32_dpp v26, v24, v26 quad_perm:[1,0,3,2] row_mask:0xf bank_mask:0xf
    v_add_f32_dpp v27, v25, v27 quad_perm:[1,0,3,2] row_mask:0xf bank_mask:0xf
    v_cndmask_b32 v24, v27, v26, s[54:55]
    v_cndmask_b32 v25, v26, v27, s[54:55]
    s_nop 1
    v_add_f32_dpp v38, v24, v25 quad_perm:[2,3,0,1] row_mask:0xf bank_mask:0xf
    s_waitcnt vmcnt(20)
    v_dot2_f32_bf16 v24, v148, v4, 0
    v_dot2_f32_bf16 v24, v149, v5, v24
    v_dot2_f32_bf16 v24, v150, v6, v24
    v_dot2_f32_bf16 v24, v151, v7, v24
    s_add_u32 s44, s37, 16384
    buffer_load_dwordx4 v[148:151], v2, s[32:35], s44 offen nt
    s_waitcnt vmcnt(20)
    v_dot2_f32_bf16 v25, v152, v4, 0
    v_dot2_f32_bf16 v25, v153, v5, v25
    v_dot2_f32_bf16 v25, v154, v6, v25
    v_dot2_f32_bf16 v25, v155, v7, v25
    buffer_load_dwordx4 v[152:155], v2, s[32:35], s44 offen offset:1024 nt
    s_waitcnt vmcnt(20)
    v_dot2_f32_bf16 v26, v156, v4, 0
    v_dot2_f32_bf16 v26, v157, v5, v26
    v_dot2_f32_bf16 v26, v158, v6, v26
    v_dot2_f32_bf16 v26, v159, v7, v26
    buffer_load_dwordx4 v[156:159], v2, s[32:35], s44 offen offset:2048 nt
    s_waitcnt vmcnt(20)
    v_dot2_f32_bf16 v27, v160, v4, 0
    v_dot2_f32_bf16 v27, v161, v5, v27
    v_dot2_f32_bf16 v27, v162, v6, v27
    v_dot2_f32_bf16 v27, v163, v7, v27
    buffer_load_dwordx4 v[160:163], v2, s[32:35], s44 offen offset:3072 nt
    s_nop 1
    v_add_f32_dpp v24, v24, v24 row_mirror row_mask:0xf bank_mask:0x3
    v_add_f32_dpp v25, v25, v25 row_mirror row_mask:0xf bank_mask:0x3
    v_add_f32_dpp v24, v26, v26 row_mirror row_mask:0xf bank_mask:0xc
    v_add_f32_dpp v25, v27, v27 row_mirror row_mask:0xf bank_mask:0xc
    s_nop 0
    v_add_f32_dpp v32, v24, v24 row_half_mirror row_mask:0xf bank_mask:0x5
    v_add_f32_dpp v32, v25, v25 row_half_mirror row_mask:0xf bank_mask:0xa
    s_waitcnt vmcnt(20)
    v_dot2_f32_bf16 v24, v164, v4, 0
    v_dot2_f32_bf16 v24, v165, v5, v24
    v_dot2_f32_bf16 v24, v166, v6, v24
    v_dot2_f32_bf16 v24, v167, v7, v24
    s_add_u32 s44, s37, 20480
    buffer_load_dwordx4 v[164:167], v2, s[32:35], s44 offen nt
    s_waitcnt vmcnt(20)
    v_dot2_f32_bf16 v25, v168, v4, 0
    v_dot2_f32_bf16 v25, v169, v5, v25
    v_dot2_f32_bf16 v25, v170, v6, v25
    v_dot2_f32_bf16 v25, v171, v7, v25
    buffer_load_dwordx4 v[168:171], v2, s[32:35], s44 offen offset:1024 nt
    s_waitcnt vmcnt(20)
    v_dot2_f32_bf16 v26, v172, v4, 0
    v_dot2_f32_bf16 v26, v173, v5, v26
    v_dot2_f32_bf16 v26, v174, v6, v26
    v_dot2_f32_bf16 v26, v175, v7, v26
    buffer_load_dwordx4 v[172:175], v2, s[32:35], s44 offen offset:2048 nt
    s_waitcnt vmcnt(20)
    v_dot2_f32_bf16 v27, v176, v4, 0
    v_dot2_f32_bf16 v27, v177, v5, v27
    v_dot2_f32_bf16 v27, v178, v6, v27
    v_dot2_f32_bf16 v27, v179, v7, v27
    buffer_load_dwordx4 v[176:179], v2, s[32:35], s44 offen offset:3072 nt
    s_nop 1
    v_add_f32_dpp v24, v24, v24 row_mirror row_mask:0xf bank_mask:0x3
    v_add_f32_dpp v25, v25, v25 row_mirror row_mask:0xf bank_mask:0x3
    v_add_f32_dpp v24, v26, v26 row_mirror row_mask:0xf bank_mask:0xc
    v_add_f32_dpp v25, v27, v27 row_mirror row_mask:0xf bank_mask:0xc
    s_nop 0
    v_add_f32_dpp v33, v24, v24 row_half_mirror row_mask:0xf bank_mask:0x5
    v_add_f32_dpp v33, v25, v25 row_half_mirror row_mask:0xf bank_mask:0xa
    s_waitcnt vmcnt(20)
    v_dot2_f32_bf16 v24, v180, v4, 0
    v_dot2_f32_bf16 v24, v181, v5, v24
    v_dot2_f32_bf16 v24, v182, v6, v24
    v_dot2_f32_bf16 v24, v183, v7, v24
    s_add_u32 s44, s37, 24576
    buffer_load_dwordx4 v[180:183], v2, s[32:35], s44 offen nt
    s_waitcnt vmcnt(20)
    v_dot2_f32_bf16 v25, v184, v4, 0
    v_dot2_f32_bf16 v25, v185, v5, v25
    v_dot2_f32_bf16 v25, v186, v6, v25
    v_dot2_f32_bf16 v25, v187, v7, v25
    buffer_load_dwordx4 v[184:187], v2, s[32:35], s44 offen offset:1024 nt
    s_waitcnt vmcnt(20)
    v_dot2_f32_bf16 v26, v188, v4, 0
    v_dot2_f32_bf16 v26, v189, v5, v26
    v_dot2_f32_bf16 v26, v190, v6, v26
    v_dot2_f32_bf16 v26, v191, v7, v26
    buffer_load_dwordx4 v[188:191], v2, s[32:35], s44 offen offset:2048 nt
    s_waitcnt vmcnt(20)
    v_dot2_f32_bf16 v27, v192, v4, 0
    v_dot2_f32_bf16 v27, v193, v5, v27
    v_dot2_f32_bf16 v27, v194, v6, v27
    v_dot2_f32_bf16 v27, v195, v7, v27
    buffer_load_dwordx4 v[192:195], v2, s[32:35], s44 offen offset:3072 nt
    s_nop 1
    v_add_f32_dpp v24, v24, v24 row_mirror row_mask:0xf bank_mask:0x3
    v_add_f32_dpp v25, v25, v25 row_mirror row_mask:0xf bank_mask:0x3
    v_add_f32_dpp v24, v26, v26 row_mirror row_mask:0xf bank_mask:0xc
    v_add_f32_dpp v25, v27, v27 row_mirror row_mask:0xf bank_mask:0xc
    s_nop 0
    v_add_f32_dpp v34, v24, v24 row_half_mirror row_mask:0xf bank_mask:0x5
    v_add_f32_dpp v34, v25, v25 row_half_mirror row_mask:0xf bank_mask:0xa
    s_waitcnt vmcnt(20)
    v_dot2_f32_bf16 v24, v196, v4, 0
    v_dot2_f32_bf16 v24, v197, v5, v24
    v_dot2_f32_bf16 v24, v198, v6, v24
    v_dot2_f32_bf16 v24, v199, v7, v24
    s_add_u32 s44, s37, 28672
    buffer_load_dwordx4 v[196:199], v2, s[32:35], s44 offen nt
    s_waitcnt vmcnt(20)
    v_dot2_f32_bf16 v25, v200, v4, 0
    v_dot2_f32_bf16 v25, v201, v5, v25
    v_dot2_f32_bf16 v25, v202, v6, v25
    v_dot2_f32_bf16 v25, v203, v7, v25
    buffer_load_dwordx4 v[200:203], v2, s[32:35], s44 offen offset:1024 nt
    s_waitcnt vmcnt(20)
    v_dot2_f32_bf16 v26, v204, v4, 0
    v_dot2_f32_bf16 v26, v205, v5, v26
    v_dot2_f32_bf16 v26, v206, v6, v26
    v_dot2_f32_bf16 v26, v207, v7, v26
    buffer_load_dwordx4 v[204:207], v2, s[32:35], s44 offen offset:2048 nt
    s_waitcnt vmcnt(20)
    v_dot2_f32_bf16 v27, v208, v4, 0
    v_dot2_f32_bf16 v27, v209, v5, v27
    v_dot2_f32_bf16 v27, v210, v6, v27
    v_dot2_f32_bf16 v27, v211, v7, v27
    buffer_load_dwordx4 v[208:211], v2, s[32:35], s44 offen offset:3072 nt
    s_nop 1
    v_add_f32_dpp v24, v24, v24 row_mirror row_mask:0xf bank_mask:0x3
    v_add_f32_dpp v25, v25, v25 row_mirror row_mask:0xf bank_mask:0x3
    v_add_f32_dpp v24, v26, v26 row_mirror row_mask:0xf bank_mask:0xc
    v_add_f32_dpp v25, v27, v27 row_mirror row_mask:0xf bank_mask:0xc
    s_nop 0
    v_add_f32_dpp v35, v24, v24 row_half_mirror row_mask:0xf bank_mask:0x5
    v_add_f32_dpp v35, v25, v25 row_half_mirror row_mask:0xf bank_mask:0xa
    v_cndmask_b32 v24, v33, v32, s[52:53]
    v_cndmask_b32 v25, v35, v34, s[52:53]
    v_cndmask_b32 v26, v32, v33, s[52:53]
    v_cndmask_b32 v27, v34, v35, s[52:53]
    s_nop 0
    v_add_f32_dpp v26, v24, v26 quad_perm:[1,0,3,2] row_mask:0xf bank_mask:0xf
    v_add_f32_dpp v27, v25, v27 quad_perm:[1,0,3,2] row_mask:0xf bank_mask:0xf
    v_cndmask_b32 v24, v27, v26, s[54:55]
    v_cndmask_b32 v25, v26, v27, s[54:55]
    s_nop 1
    v_add_f32_dpp v39, v24, v25 quad_perm:[2,3,0,1] row_mask:0xf bank_mask:0xf
    s_branch L_kdone
L_kb3:
    s_waitcnt vmcnt(21)
    v_dot2_f32_bf16 v24, v84, v4, 0
    v_dot2_f32_bf16 v24, v85, v5, v24
    v_dot2_f32_bf16 v24, v86, v6, v24
    v_dot2_f32_bf16 v24, v87, v7, v24
    buffer_load_dwordx4 v[84:87], v2, s[32:35], s37 offen nt
    s_waitcnt vmcnt(21)
    v_dot2_f32_bf16 v25, v88, v4, 0
    v_dot2_f32_bf16 v25, v89, v5, v25
    v_dot2_f32_bf16 v25, v90, v6, v25
    v_dot2_f32_bf16 v25, v91, v7, v25
    buffer_load_dwordx4 v[88:91], v2, s[32:35], s37 offen offset:1024 nt
    s_waitcnt vmcnt(21)
    v_dot2_f32_bf16 v26, v92, v4, 0
    v_dot2_f32_bf16 v26, v93, v5, v26
    v_dot2_f32_bf16 v26, v94, v6, v26
    v_dot2_f32_bf16 v26, v95, v7, v26
    buffer_load_dwordx4 v[92:95], v2, s[32:35], s37 offen offset:2048 nt
    s_waitcnt vmcnt(21)
    v_dot2_f32_bf16 v27, v96, v4, 0
    v_dot2_f32_bf16 v27, v97, v5, v27
    v_dot2_f32_bf16 v27, v98, v6, v27
    v_dot2_f32_bf16 v27, v99, v7, v27
    buffer_load_dwordx4 v[96:99], v2, s[32:35], s37 offen offset:3072 nt
    s_nop 1
    v_add_f32_dpp v24, v24, v24 row_mirror row_mask:0xf bank_mask:0x3
    v_add_f32_dpp v25, v25, v25 row_mirror row_mask:0xf bank_mask:0x3
    v_add_f32_dpp v24, v26, v26 row_mirror row_mask:0xf bank_mask:0xc
    v_add_f32_dpp v25, v27, v27 row_mirror row_mask:0xf bank_mask:0xc
    s_nop 0
    v_add_f32_dpp v32, v24, v24 row_half_mirror row_mask:0xf bank_mask:0x5
    v_add_f32_dpp v32, v25, v25 row_half_mirror row_mask:0xf bank_mask:0xa
    s_waitcnt vmcnt(21)
    v_dot2_f32_bf16 v24, v100, v4, 0
    v_dot2_f32_bf16 v24, v101, v5, v24
    v_dot2_f32_bf16 v24, v102, v6, v24
    v_dot2_f32_bf16 v24, v103, v7, v24
    s_add_u32 s44, s37, 4096
    buffer_load_dwordx4 v[100:103], v2, s[32:35], s44 offen nt
    s_waitcnt vmcnt(21)
    v_dot2_f32_bf16 v25, v104, v4, 0
    v_dot2_f32_bf16 v25, v105, v5, v25
    v_dot2_f32_bf16 v25, v106, v6, v25
    v_dot2_f32_bf16 v25, v107, v7, v25
    buffer_load_dwordx4 v[104:107], v2, s[32:35], s44 offen offset:1024 nt
    s_waitcnt vmcnt(21)
    v_dot2_f32_bf16 v26, v108, v4, 0
    v_dot2_f32_bf16 v26, v109, v5, v26
    v_dot2_f32_bf16 v26, v110, v6, v26
    v_dot2_f32_bf16 v26, v111, v7, v26
    buffer_load_dwordx4 v[108:111], v2, s[32:35], s44 offen offset:2048 nt
    s_waitcnt vmcnt(21)
    v_dot2_f32_bf16 v27, v112, v4, 0
    v_dot2_f32_bf16 v27, v113, v5, v27
    v_dot2_f32_bf16 v27, v114, v6, v27
    v_dot2_f32_bf16 v27, v115, v7, v27
    buffer_load_dwordx4 v[112:115], v2, s[32:35], s44 offen offset:3072 nt
    s_nop 1
    v_add_f32_dpp v24, v24, v24 row_mirror row_mask:0xf bank_mask:0x3
    v_add_f32_dpp v25, v25, v25 row_mirror row_mask:0xf bank_mask:0x3
    v_add_f32_dpp v24, v26, v26 row_mirror row_mask:0xf bank_mask:0xc
    v_add_f32_dpp v25, v27, v27 row_mirror row_mask:0xf bank_mask:0xc
    s_nop 0
    v_add_f32_dpp v33, v24, v24 row_half_mirror row_mask:0xf bank_mask:0x5
    v_add_f32_dpp v33, v25, v25 row_half_mirror row_mask:0xf bank_mask:0xa
    s_waitcnt vmcnt(21)
    v_dot2_f32_bf16 v24, v116, v4, 0
    v_dot2_f32_bf16 v24, v117, v5, v24
    v_dot2_f32_bf16 v24, v118, v6, v24
    v_dot2_f32_bf16 v24, v119, v7, v24
    s_add_u32 s44, s37, 8192
    buffer_load_dwordx4 v[116:119], v2, s[32:35], s44 offen nt
    s_waitcnt vmcnt(21)
    v_dot2_f32_bf16 v25, v120, v4, 0
    v_dot2_f32_bf16 v25, v121, v5, v25
    v_dot2_f32_bf16 v25, v122, v6, v25
    v_dot2_f32_bf16 v25, v123, v7, v25
    buffer_load_dwordx4 v[120:123], v2, s[32:35], s44 offen offset:1024 nt
    s_waitcnt vmcnt(21)
    v_dot2_f32_bf16 v26, v124, v4, 0
    v_dot2_f32_bf16 v26, v125, v5, v26
    v_dot2_f32_bf16 v26, v126, v6, v26
    v_dot2_f32_bf16 v26, v127, v7, v26
    buffer_load_dwordx4 v[124:127], v2, s[32:35], s44 offen offset:2048 nt
    s_waitcnt vmcnt(21)
    v_dot2_f32_bf16 v27, v128, v4, 0
    v_dot2_f32_bf16 v27, v129, v5, v27
    v_dot2_f32_bf16 v27, v130, v6, v27
    v_dot2_f32_bf16 v27, v131, v7, v27
    buffer_load_dwordx4 v[128:131], v2, s[32:35], s44 offen offset:3072 nt
    s_nop 1
    v_add_f32_dpp v24, v24, v24 row_mirror row_mask:0xf bank_mask:0x3
    v_add_f32_dpp v25, v25, v25 row_mirror row_mask:0xf bank_mask:0x3
    v_add_f32_dpp v24, v26, v26 row_mirror row_mask:0xf bank_mask:0xc
    v_add_f32_dpp v25, v27, v27 row_mirror row_mask:0xf bank_mask:0xc
    s_nop 0
    v_add_f32_dpp v34, v24, v24 row_half_mirror row_mask:0xf bank_mask:0x5
    v_add_f32_dpp v34, v25, v25 row_half_mirror row_mask:0xf bank_mask:0xa
    s_waitcnt vmcnt(21)
    v_dot2_f32_bf16 v24, v132, v4, 0
    v_dot2_f32_bf16 v24, v133, v5, v24
    v_dot2_f32_bf16 v24, v134, v6, v24
    v_dot2_f32_bf16 v24, v135, v7, v24
    s_add_u32 s44, s37, 12288
    buffer_load_dwordx4 v[132:135], v2, s[32:35], s44 offen nt
    s_waitcnt vmcnt(21)
    v_dot2_f32_bf16 v25, v136, v4, 0
    v_dot2_f32_bf16 v25, v137, v5, v25
    v_dot2_f32_bf16 v25, v138, v6, v25
    v_dot2_f32_bf16 v25, v139, v7, v25
    buffer_load_dwordx4 v[136:139], v2, s[32:35], s44 offen offset:1024 nt
    s_waitcnt vmcnt(21)
    v_dot2_f32_bf16 v26, v140, v4, 0
    v_dot2_f32_bf16 v26, v141, v5, v26
    v_dot2_f32_bf16 v26, v142, v6, v26
    v_dot2_f32_bf16 v26, v143, v7, v26
    buffer_load_dwordx4 v[140:143], v2, s[32:35], s44 offen offset:2048 nt
    s_waitcnt vmcnt(21)
    v_dot2_f32_bf16 v27, v144, v4, 0
    v_dot2_f32_bf16 v27, v145, v5, v27
    v_dot2_f32_bf16 v27, v146, v6, v27
    v_dot2_f32_bf16 v27, v147, v7, v27
    buffer_load_dwordx4 v[144:147], v2, s[32:35], s44 offen offset:3072 nt
    s_nop 1
    v_add_f32_dpp v24, v24, v24 row_mirror row_mask:0xf bank_mask:0x3
    v_add_f32_dpp v25, v25, v25 row_mirror row_mask:0xf bank_mask:0x3
    v_add_f32_dpp v24, v26, v26 row_mirror row_mask:0xf bank_mask:0xc
    v_add_f32_dpp v25, v27, v27 row_mirror row_mask:0xf bank_mask:0xc
    s_nop 0
    v_add_f32_dpp v35, v24, v24 row_half_mirror row_mask:0xf bank_mask:0x5
    v_add_f32_dpp v35, v25, v25 row_half_mirror row_mask:0xf bank_mask:0xa
    v_cndmask_b32 v24, v33, v32, s[52:53]
    v_cndmask_b32 v25, v35, v34, s[52:53]
    v_cndmask_b32 v26, v32, v33, s[52:53]
    v_cndmask_b32 v27, v34, v35, s[52:53]
    s_nop 0
    v_add_f32_dpp v26, v24, v26 quad_perm:[1,0,3,2] row_mask:0xf bank_mask:0xf
    v_add_f32_dpp v27, v25, v27 quad_perm:[1,0,3,2] row_mask:0xf bank_mask:0xf
    v_cndmask_b32 v24, v27, v26, s[54:55]
    v_cndmask_b32 v25, v26, v27, s[54:55]
    s_nop 1
    v_add_f32_dpp v38, v24, v25 quad_perm:[2,3,0,1] row_mask:0xf bank_mask:0xf
    s_waitcnt vmcnt(21)
    v_dot2_f32_bf16 v24, v148, v4, 0
    v_dot2_f32_bf16 v24, v149, v5, v24
    v_dot2_f32_bf16 v24, v150, v6, v24
    v_dot2_f32_bf16 v24, v151, v7, v24
    s_add_u32 s44, s37, 16384
    buffer_load_dwordx4 v[148:151], v2, s[32:35], s44 offen nt
    s_waitcnt vmcnt(21)
    v_dot2_f32_bf16 v25, v152, v4, 0
    v_dot2_f32_bf16 v25, v153, v5, v25
    v_dot2_f32_bf16 v25, v154, v6, v25
    v_dot2_f32_bf16 v25, v155, v7, v25
    buffer_load_dwordx4 v[152:155], v2, s[32:35], s44 offen offset:1024 nt
    s_waitcnt vmcnt(21)
    v_dot2_f32_bf16 v26, v156, v4, 0
    v_dot2_f32_bf16 v26, v157, v5, v26
    v_dot2_f32_bf16 v26, v158, v6, v26
    v_dot2_f32_bf16 v26, v159, v7, v26
    buffer_load_dwordx4 v[156:159], v2, s[32:35], s44 offen offset:2048 nt
    s_waitcnt vmcnt(21)
    v_dot2_f32_bf16 v27, v160, v4, 0
    v_dot2_f32_bf16 v27, v161, v5, v27
    v_dot2_f32_bf16 v27, v162, v6, v27
    v_dot2_f32_bf16 v27, v163, v7, v27
    buffer_load_dwordx4 v[160:163], v2, s[32:35], s44 offen offset:3072 nt
    s_nop 1
    v_add_f32_dpp v24, v24, v24 row_mirror row_mask:0xf bank_mask:0x3
    v_add_f32_dpp v25, v25, v25 row_mirror row_mask:0xf bank_mask:0x3
    v_add_f32_dpp v24, v26, v26 row_mirror row_mask:0xf bank_mask:0xc
    v_add_f32_dpp v25, v27, v27 row_mirror row_mask:0xf bank_mask:0xc
    s_nop 0
    v_add_f32_dpp v32, v24, v24 row_half_mirror row_mask:0xf bank_mask:0x5
    v_add_f32_dpp v32, v25, v25 row_half_mirror row_mask:0xf bank_mask:0xa
    s_waitcnt vmcnt(21)
    v_dot2_f32_bf16 v24, v164, v4, 0
    v_dot2_f32_bf16 v24, v165, v5, v24
    v_dot2_f32_bf16 v24, v166, v6, v24
    v_dot2_f32_bf16 v24, v167, v7, v24
    s_add_u32 s44, s37, 20480
    buffer_load_dwordx4 v[164:167], v2, s[32:35], s44 offen nt
    s_waitcnt vmcnt(21)
    v_dot2_f32_bf16 v25, v168, v4, 0
    v_dot2_f32_bf16 v25, v169, v5, v25
    v_dot2_f32_bf16 v25, v170, v6, v25
    v_dot2_f32_bf16 v25, v171, v7, v25
    buffer_load_dwordx4 v[168:171], v2, s[32:35], s44 offen offset:1024 nt
    s_waitcnt vmcnt(21)
    v_dot2_f32_bf16 v26, v172, v4, 0
    v_dot2_f32_bf16 v26, v173, v5, v26
    v_dot2_f32_bf16 v26, v174, v6, v26
    v_dot2_f32_bf16 v26, v175, v7, v26
    buffer_load_dwordx4 v[172:175], v2, s[32:35], s44 offen offset:2048 nt
    s_waitcnt vmcnt(21)
    v_dot2_f32_bf16 v27, v176, v4, 0
    v_dot2_f32_bf16 v27, v177, v5, v27
    v_dot2_f32_bf16 v27, v178, v6, v27
    v_dot2_f32_bf16 v27, v179, v7, v27
    buffer_load_dwordx4 v[176:179], v2, s[32:35], s44 offen offset:3072 nt
    s_nop 1
    v_add_f32_dpp v24, v24, v24 row_mirror row_mask:0xf bank_mask:0x3
    v_add_f32_dpp v25, v25, v25 row_mirror row_mask:0xf bank_mask:0x3
    v_add_f32_dpp v24, v26, v26 row_mirror row_mask:0xf bank_mask:0xc
    v_add_f32_dpp v25, v27, v27 row_mirror row_mask:0xf bank_mask:0xc
    s_nop 0
    v_add_f32_dpp v33, v24, v24 row_half_mirror row_mask:0xf bank_mask:0x5
    v_add_f32_dpp v33, v25, v25 row_half_mirror row_mask:0xf bank_mask:0xa
    s_waitcnt vmcnt(21)
    v_dot2_f32_bf16 v24, v180, v4, 0
    v_dot2_f32_bf16 v24, v181, v5, v24
    v_dot2_f32_bf16 v24, v182, v6, v24
    v_dot2_f32_bf16 v24, v183, v7, v24
    s_add_u32 s44, s37, 24576
    buffer_load_dwordx4 v[180:183], v2, s[32:35], s44 offen nt
    s_waitcnt vmcnt(21)
    v_dot2_f32_bf16 v25, v184, v4, 0
    v_dot2_f32_bf16 v25, v185, v5, v25
    v_dot2_f32_bf16 v25, v186, v6, v25
    v_dot2_f32_bf16 v25, v187, v7, v25
    buffer_load_dwordx4 v[184:187], v2, s[32:35], s44 offen offset:1024 nt
    s_waitcnt vmcnt(21)
    v_dot2_f32_bf16 v26, v188, v4, 0
    v_dot2_f32_bf16 v26, v189, v5, v26
    v_dot2_f32_bf16 v26, v190, v6, v26
    v_dot2_f32_bf16 v26, v191, v7, v26
    buffer_load_dwordx4 v[188:191], v2, s[32:35], s44 offen offset:2048 nt
    s_waitcnt vmcnt(21)
    v_dot2_f32_bf16 v27, v192, v4, 0
    v_dot2_f32_bf16 v27, v193, v5, v27
    v_dot2_f32_bf16 v27, v194, v6, v27
    v_dot2_f32_bf16 v27, v195, v7, v27
    buffer_load_dwordx4 v[192:195], v2, s[32:35], s44 offen offset:3072 nt
    s_nop 1
    v_add_f32_dpp v24, v24, v24 row_mirror row_mask:0xf bank_mask:0x3
    v_add_f32_dpp v25, v25, v25 row_mirror row_mask:0xf bank_mask:0x3
    v_add_f32_dpp v24, v26, v26 row_mirror row_mask:0xf bank_mask:0xc
    v_add_f32_dpp v25, v27, v27 row_mirror row_mask:0xf bank_mask:0xc
    s_nop 0
    v_add_f32_dpp v34, v24, v24 row_half_mirror row_mask:0xf bank_mask:0x5
    v_add_f32_dpp v34, v25, v25 row_half_mirror row_mask:0xf bank_mask:0xa
    s_waitcnt vmcnt(21)
    v_dot2_f32_bf16 v24, v196, v4, 0
    v_dot2_f32_bf16 v24, v197, v5, v24
    v_dot2_f32_bf16 v24, v198, v6, v24
    v_dot2_f32_bf16 v24, v199, v7, v24
    s_add_u32 s44, s37, 28672
    buffer_load_dwordx4 v[196:199], v2, s[32:35], s44 offen nt
    s_waitcnt vmcnt(21)
    v_dot2_f32_bf16 v25, v200, v4, 0
    v_dot2_f32_bf16 v25, v201, v5, v25
    v_dot2_f32_bf16 v25, v202, v6, v25
    v_dot2_f32_bf16 v25, v203, v7, v25
    buffer_load_dwordx4 v[200:203], v2, s[32:35], s44 offen offset:1024 nt
    s_waitcnt vmcnt(21)
    v_dot2_f32_bf16 v26, v204, v4, 0
    v_dot2_f32_bf16 v26, v205, v5, v26
    v_dot2_f32_bf16 v26, v206, v6, v26
    v_dot2_f32_bf16 v26, v207, v7, v26
    buffer_load_dwordx4 v[204:207], v2, s[32:35], s44 offen offset:2048 nt
    s_waitcnt vmcnt(21)
    v_dot2_f32_bf16 v27, v208, v4, 0
    v_dot2_f32_bf16 v27, v209, v5, v27
    v_dot2_f32_bf16 v27, v210, v6, v27
    v_dot2_f32_bf16 v27, v211, v7, v27
    buffer_load_dwordx4 v[208:211], v2, s[32:35], s44 offen offset:3072 nt
    s_nop 1
    v_add_f32_dpp v24, v24, v24 row_mirror row_mask:0xf bank_mask:0x3
    v_add_f32_dpp v25, v25, v25 row_mirror row_mask:0xf bank_mask:0x3
    v_add_f32_dpp v24, v26, v26 row_mirror row_mask:0xf bank_mask:0xc
    v_add_f32_dpp v25, v27, v27 row_mirror row_mask:0xf bank_mask:0xc
    s_nop 0
    v_add_f32_dpp v35, v24, v24 row_half_mirror row_mask:0xf bank_mask:0x5
    v_add_f32_dpp v35, v25, v25 row_half_mirror row_mask:0xf bank_mask:0xa
    v_cndmask_b32 v24, v33, v32, s[52:53]
    v_cndmask_b32 v25, v35, v34, s[52:53]
    v_cndmask_b32 v26, v32, v33, s[52:53]
    v_cndmask_b32 v27, v34, v35, s[52:53]
    s_nop 0
    v_add_f32_dpp v26, v24, v26 quad_perm:[1,0,3,2] row_mask:0xf bank_mask:0xf
    v_add_f32_dpp v27, v25, v27 quad_perm:[1,0,3,2] row_mask:0xf bank_mask:0xf
    v_cndmask_b32 v24, v27, v26, s[54:55]
    v_cndmask_b32 v25, v26, v27, s[54:55]
    s_nop 1
    v_add_f32_dpp v39, v24, v25 quad_perm:[2,3,0,1] row_mask:0xf bank_mask:0xf
    s_branch L_kdone
L_kb4:
    s_waitcnt vmcnt(23)
    v_dot2_f32_bf16 v24, v84, v4, 0
    v_dot2_f32_bf16 v24, v85, v5, v24
    v_dot2_f32_bf16 v24, v86, v6, v24
    v_dot2_f32_bf16 v24, v87, v7, v24
    buffer_load_dwordx4 v[84:87], v2, s[32:35], s37 offen nt
    s_waitcnt vmcnt(23)
    v_dot2_f32_bf16 v25, v88, v4, 0
    v_dot2_f32_bf16 v25, v89, v5, v25
    v_dot2_f32_bf16 v25, v90, v6, v25
    v_dot2_f32_bf16 v25, v91, v7, v25
    buffer_load_dwordx4 v[88:91], v2, s[32:35], s37 offen offset:1024 nt
    s_waitcnt vmcnt(23)
    v_dot2_f32_bf16 v26, v92, v4, 0
    v_dot2_f32_bf16 v26, v93, v5, v26
    v_dot2_f32_bf16 v26, v94, v6, v26
    v_dot2_f32_bf16 v26, v95, v7, v26
    buffer_load_dwordx4 v[92:95], v2, s[32:35], s37 offen offset:2048 nt
    s_waitcnt vmcnt(23)
    v_dot2_f32_bf16 v27, v96, v4, 0
    v_dot2_f32_bf16 v27, v97, v5, v27
    v_dot2_f32_bf16 v27, v98, v6, v27
    v_dot2_f32_bf16 v27, v99, v7, v27
    buffer_load_dwordx4 v[96:99], v2, s[32:35], s37 offen offset:3072 nt
    s_nop 1
    v_add_f32_dpp v24, v24, v24 row_mirror row_mask:0xf bank_mask:0x3
    v_add_f32_dpp v25, v25, v25 row_mirror row_mask:0xf bank_mask:0x3
    v_add_f32_dpp v24, v26, v26 row_mirror row_mask:0xf bank_mask:0xc
    v_add_f32_dpp v25, v27, v27 row_mirror row_mask:0xf bank_mask:0xc
    s_nop 0
    v_add_f32_dpp v32, v24, v24 row_half_mirror row_mask:0xf bank_mask:0x5
    v_add_f32_dpp v32, v25, v25 row_half_mirror row_mask:0xf bank_mask:0xa
    s_waitcnt vmcnt(23)
    v_dot2_f32_bf16 v24, v100, v4, 0
    v_dot2_f32_bf16 v24, v101, v5, v24
    v_dot2_f32_bf16 v24, v102, v6, v24
    v_dot2_f32_bf16 v24, v103, v7, v24
    s_add_u32 s44, s37, 4096
    buffer_load_dwordx4 v[100:103], v2, s[32:35], s44 offen nt
    s_waitcnt vmcnt(23)
    v_dot2_f32_bf16 v25, v104, v4, 0
    v_dot2_f32_bf16 v25, v105, v5, v25
    v_dot2_f32_bf16 v25, v106, v6, v25
    v_dot2_f32_bf16 v25, v107, v7, v25
    buffer_load_dwordx4 v[104:107], v2, s[32:35], s44 offen offset:1024 nt
    s_waitcnt vmcnt(23)
    v_dot2_f32_bf16 v26, v108, v4, 0
    v_dot2_f32_bf16 v26, v109, v5, v26
    v_dot2_f32_bf16 v26, v110, v6, v26
    v_dot2_f32_bf16 v26, v111, v7, v26
    buffer_load_dwordx4 v[108:111], v2, s[32:35], s44 offen offset:2048 nt
    s_waitcnt vmcnt(23)
    v_dot2_f32_bf16 v27, v112, v4, 0
    v_dot2_f32_bf16 v27, v113, v5, v27
    v_dot2_f32_bf16 v27, v114, v6, v27
    v_dot2_f32_bf16 v27, v115, v7, v27
    buffer_load_dwordx4 v[112:115], v2, s[32:35], s44 offen offset:3072 nt
    s_nop 1
    v_add_f32_dpp v24, v24, v24 row_mirror row_mask:0xf bank_mask:0x3
    v_add_f32_dpp v25, v25, v25 row_mirror row_mask:0xf bank_mask:0x3
    v_add_f32_dpp v24, v26, v26 row_mirror row_mask:0xf bank_mask:0xc
    v_add_f32_dpp v25, v27, v27 row_mirror row_mask:0xf bank_mask:0xc
    s_nop 0
    v_add_f32_dpp v33, v24, v24 row_half_mirror row_mask:0xf bank_mask:0x5
    v_add_f32_dpp v33, v25, v25 row_half_mirror row_mask:0xf bank_mask:0xa
    s_waitcnt vmcnt(23)
    v_dot2_f32_bf16 v24, v116, v4, 0
    v_dot2_f32_bf16 v24, v117, v5, v24
    v_dot2_f32_bf16 v24, v118, v6, v24
    v_dot2_f32_bf16 v24, v119, v7, v24
    s_add_u32 s44, s37, 8192
    buffer_load_dwordx4 v[116:119], v2, s[32:35], s44 offen nt
    s_waitcnt vmcnt(23)
    v_dot2_f32_bf16 v25, v120, v4, 0
    v_dot2_f32_bf16 v25, v121, v5, v25
    v_dot2_f32_bf16 v25, v122, v6, v25
    v_dot2_f32_bf16 v25, v123, v7, v25
    buffer_load_dwordx4 v[120:123], v2, s[32:35], s44 offen offset:1024 nt
    s_waitcnt vmcnt(23)
    v_dot2_f32_bf16 v26, v124, v4, 0
    v_dot2_f32_bf16 v26, v125, v5, v26
    v_dot2_f32_bf16 v26, v126, v6, v26
    v_dot2_f32_bf16 v26, v127, v7, v26
    buffer_load_dwordx4 v[124:127], v2, s[32:35], s44 offen offset:2048 nt
    s_waitcnt vmcnt(23)
    v_dot2_f32_bf16 v27, v128, v4, 0
    v_dot2_f32_bf16 v27, v129, v5, v27
    v_dot2_f32_bf16 v27, v130, v6, v27
    v_dot2_f32_bf16 v27, v131, v7, v27
    buffer_load_dwordx4 v[128:131], v2, s[32:35], s44 offen offset:3072 nt
    s_nop 1
    v_add_f32_dpp v24, v24, v24 row_mirror row_mask:0xf bank_mask:0x3
    v_add_f32_dpp v25, v25, v25 row_mirror row_mask:0xf bank_mask:0x3
    v_add_f32_dpp v24, v26, v26 row_mirror row_mask:0xf bank_mask:0xc
    v_add_f32_dpp v25, v27, v27 row_mirror row_mask:0xf bank_mask:0xc
    s_nop 0
    v_add_f32_dpp v34, v24, v24 row_half_mirror row_mask:0xf bank_mask:0x5
    v_add_f32_dpp v34, v25, v25 row_half_mirror row_mask:0xf bank_mask:0xa
    s_waitcnt vmcnt(23)
    v_dot2_f32_bf16 v24, v132, v4, 0
    v_dot2_f32_bf16 v24, v133, v5, v24
    v_dot2_f32_bf16 v24, v134, v6, v24
    v_dot2_f32_bf16 v24, v135, v7, v24
    s_add_u32 s44, s37, 12288
    buffer_load_dwordx4 v[132:135], v2, s[32:35], s44 offen nt
    s_waitcnt vmcnt(23)
    v_dot2_f32_bf16 v25, v136, v4, 0
    v_dot2_f32_bf16 v25, v137, v5, v25
    v_dot2_f32_bf16 v25, v138, v6, v25
    v_dot2_f32_bf16 v25, v139, v7, v25
    buffer_load_dwordx4 v[136:139], v2, s[32:35], s44 offen offset:1024 nt
    s_waitcnt vmcnt(23)
    v_dot2_f32_bf16 v26, v140, v4, 0
    v_dot2_f32_bf16 v26, v141, v5, v26
    v_dot2_f32_bf16 v26, v142, v6, v26
    v_dot2_f32_bf16 v26, v143, v7, v26
    buffer_load_dwordx4 v[140:143], v2, s[32:35], s44 offen offset:2048 nt
    s_waitcnt vmcnt(23)
    v_dot2_f32_bf16 v27, v144, v4, 0
    v_dot2_f32_bf16 v27, v145, v5, v27
    v_dot2_f32_bf16 v27, v146, v6, v27
    v_dot2_f32_bf16 v27, v147, v7, v27
    buffer_load_dwordx4 v[144:147], v2, s[32:35], s44 offen offset:3072 nt
    s_nop 1
    v_add_f32_dpp v24, v24, v24 row_mirror row_mask:0xf bank_mask:0x3
    v_add_f32_dpp v25, v25, v25 row_mirror row_mask:0xf bank_mask:0x3
    v_add_f32_dpp v24, v26, v26 row_mirror row_mask:0xf bank_mask:0xc
    v_add_f32_dpp v25, v27, v27 row_mirror row_mask:0xf bank_mask:0xc
    s_nop 0
    v_add_f32_dpp v35, v24, v24 row_half_mirror row_mask:0xf bank_mask:0x5
    v_add_f32_dpp v35, v25, v25 row_half_mirror row_mask:0xf bank_mask:0xa
    v_cndmask_b32 v24, v33, v32, s[52:53]
    v_cndmask_b32 v25, v35, v34, s[52:53]
    v_cndmask_b32 v26, v32, v33, s[52:53]
    v_cndmask_b32 v27, v34, v35, s[52:53]
    s_nop 0
    v_add_f32_dpp v26, v24, v26 quad_perm:[1,0,3,2] row_mask:0xf bank_mask:0xf
    v_add_f32_dpp v27, v25, v27 quad_perm:[1,0,3,2] row_mask:0xf bank_mask:0xf
    v_cndmask_b32 v24, v27, v26, s[54:55]
    v_cndmask_b32 v25, v26, v27, s[54:55]
    s_nop 1
    v_add_f32_dpp v38, v24, v25 quad_perm:[2,3,0,1] row_mask:0xf bank_mask:0xf
    s_waitcnt vmcnt(23)
    v_dot2_f32_bf16 v24, v148, v4, 0
    v_dot2_f32_bf16 v24, v149, v5, v24
    v_dot2_f32_bf16 v24, v150, v6, v24
    v_dot2_f32_bf16 v24, v151, v7, v24
    s_add_u32 s44, s37, 16384
    buffer_load_dwordx4 v[148:151], v2, s[32:35], s44 offen nt
    s_waitcnt vmcnt(23)
    v_dot2_f32_bf16 v25, v152, v4, 0
    v_dot2_f32_bf16 v25, v153, v5, v25
    v_dot2_f32_bf16 v25, v154, v6, v25
    v_dot2_f32_bf16 v25, v155, v7, v25
    buffer_load_dwordx4 v[152:155], v2, s[32:35], s44 offen offset:1024 nt
    s_waitcnt vmcnt(23)
    v_dot2_f32_bf16 v26, v156, v4, 0
    v_dot2_f32_bf16 v26, v157, v5, v26
    v_dot2_f32_bf16 v26, v158, v6, v26
    v_dot2_f32_bf16 v26, v159, v7, v26
    buffer_load_dwordx4 v[156:159], v2, s[32:35], s44 offen offset:2048 nt
    s_waitcnt vmcnt(23)
    v_dot2_f32_bf16 v27, v160, v4, 0
    v_dot2_f32_bf16 v27, v161, v5, v27
    v_dot2_f32_bf16 v27, v162, v6, v27
    v_dot2_f32_bf16 v27, v163, v7, v27
    buffer_load_dwordx4 v[160:163], v2, s[32:35], s44 offen offset:3072 nt
    s_nop 1
    v_add_f32_dpp v24, v24, v24 row_mirror row_mask:0xf bank_mask:0x3
    v_add_f32_dpp v25, v25, v25 row_mirror row_mask:0xf bank_mask:0x3
    v_add_f32_dpp v24, v26, v26 row_mirror row_mask:0xf bank_mask:0xc
    v_add_f32_dpp v25, v27, v27 row_mirror row_mask:0xf bank_mask:0xc
    s_nop 0
    v_add_f32_dpp v32, v24, v24 row_half_mirror row_mask:0xf bank_mask:0x5
    v_add_f32_dpp v32, v25, v25 row_half_mirror row_mask:0xf bank_mask:0xa
    s_waitcnt vmcnt(23)
    v_dot2_f32_bf16 v24, v164, v4, 0
    v_dot2_f32_bf16 v24, v165, v5, v24
    v_dot2_f32_bf16 v24, v166, v6, v24
    v_dot2_f32_bf16 v24, v167, v7, v24
    s_add_u32 s44, s37, 20480
    buffer_load_dwordx4 v[164:167], v2, s[32:35], s44 offen nt
    s_waitcnt vmcnt(23)
    v_dot2_f32_bf16 v25, v168, v4, 0
    v_dot2_f32_bf16 v25, v169, v5, v25
    v_dot2_f32_bf16 v25, v170, v6, v25
    v_dot2_f32_bf16 v25, v171, v7, v25
    buffer_load_dwordx4 v[168:171], v2, s[32:35], s44 offen offset:1024 nt
    s_waitcnt vmcnt(23)
    v_dot2_f32_bf16 v26, v172, v4, 0
    v_dot2_f32_bf16 v26, v173, v5, v26
    v_dot2_f32_bf16 v26, v174, v6, v26
    v_dot2_f32_bf16 v26, v175, v7, v26
    buffer_load_dwordx4 v[172:175], v2, s[32:35], s44 offen offset:2048 nt
    s_waitcnt vmcnt(23)
    v_dot2_f32_bf16 v27, v176, v4, 0
    v_dot2_f32_bf16 v27, v177, v5, v27
    v_dot2_f32_bf16 v27, v178, v6, v27
    v_dot2_f32_bf16 v27, v179, v7, v27
    buffer_load_dwordx4 v[176:179], v2, s[32:35], s44 offen offset:3072 nt
    s_nop 1
    v_add_f32_dpp v24, v24, v24 row_mirror row_mask:0xf bank_mask:0x3
    v_add_f32_dpp v25, v25, v25 row_mirror row_mask:0xf bank_mask:0x3
    v_add_f32_dpp v24, v26, v26 row_mirror row_mask:0xf bank_mask:0xc
    v_add_f32_dpp v25, v27, v27 row_mirror row_mask:0xf bank_mask:0xc
    s_nop 0
    v_add_f32_dpp v33, v24, v24 row_half_mirror row_mask:0xf bank_mask:0x5
    v_add_f32_dpp v33, v25, v25 row_half_mirror row_mask:0xf bank_mask:0xa
    s_waitcnt vmcnt(23)
    v_dot2_f32_bf16 v24, v180, v4, 0
    v_dot2_f32_bf16 v24, v181, v5, v24
    v_dot2_f32_bf16 v24, v182, v6, v24
    v_dot2_f32_bf16 v24, v183, v7, v24
    s_add_u32 s44, s37, 24576
    buffer_load_dwordx4 v[180:183], v2, s[32:35], s44 offen nt
    s_waitcnt vmcnt(23)
    v_dot2_f32_bf16 v25, v184, v4, 0
    v_dot2_f32_bf16 v25, v185, v5, v25
    v_dot2_f32_bf16 v25, v186, v6, v25
    v_dot2_f32_bf16 v25, v187, v7, v25
    buffer_load_dwordx4 v[184:187], v2, s[32:35], s44 offen offset:1024 nt
    s_waitcnt vmcnt(23)
    v_dot2_f32_bf16 v26, v188, v4, 0
    v_dot2_f32_bf16 v26, v189, v5, v26
    v_dot2_f32_bf16 v26, v190, v6, v26
    v_dot2_f32_bf16 v26, v191, v7, v26
    buffer_load_dwordx4 v[188:191], v2, s[32:35], s44 offen offset:2048 nt
    s_waitcnt vmcnt(23)
    v_dot2_f32_bf16 v27, v192, v4, 0
    v_dot2_f32_bf16 v27, v193, v5, v27
    v_dot2_f32_bf16 v27, v194, v6, v27
    v_dot2_f32_bf16 v27, v195, v7, v27
    buffer_load_dwordx4 v[192:195], v2, s[32:35], s44 offen offset:3072 nt
    s_nop 1
    v_add_f32_dpp v24, v24, v24 row_mirror row_mask:0xf bank_mask:0x3
    v_add_f32_dpp v25, v25, v25 row_mirror row_mask:0xf bank_mask:0x3
    v_add_f32_dpp v24, v26, v26 row_mirror row_mask:0xf bank_mask:0xc
    v_add_f32_dpp v25, v27, v27 row_mirror row_mask:0xf bank_mask:0xc
    s_nop 0
    v_add_f32_dpp v34, v24, v24 row_half_mirror row_mask:0xf bank_mask:0x5
    v_add_f32_dpp v34, v25, v25 row_half_mirror row_mask:0xf bank_mask:0xa
    s_waitcnt vmcnt(23)
    v_dot2_f32_bf16 v24, v196, v4, 0
    v_dot2_f32_bf16 v24, v197, v5, v24
    v_dot2_f32_bf16 v24, v198, v6, v24
    v_dot2_f32_bf16 v24, v199, v7, v24
    s_add_u32 s44, s37, 28672
    buffer_load_dwordx4 v[196:199], v2, s[32:35], s44 offen nt
    s_waitcnt vmcnt(23)
    v_dot2_f32_bf16 v25, v200, v4, 0
    v_dot2_f32_bf16 v25, v201, v5, v25
    v_dot2_f32_bf16 v25, v202, v6, v25
    v_dot2_f32_bf16 v25, v203, v7, v25
    buffer_load_dwordx4 v[200:203], v2, s[32:35], s44 offen offset:1024 nt
    s_waitcnt vmcnt(23)
    v_dot2_f32_bf16 v26, v204, v4, 0
    v_dot2_f32_bf16 v26, v205, v5, v26
    v_dot2_f32_bf16 v26, v206, v6, v26
    v_dot2_f32_bf16 v26, v207, v7, v26
    buffer_load_dwordx4 v[204:207], v2, s[32:35], s44 offen offset:2048 nt
    s_waitcnt vmcnt(23)
    v_dot2_f32_bf16 v27, v208, v4, 0
    v_dot2_f32_bf16 v27, v209, v5, v27
    v_dot2_f32_bf16 v27, v210, v6, v27
    v_dot2_f32_bf16 v27, v211, v7, v27
    buffer_load_dwordx4 v[208:211], v2, s[32:35], s44 offen offset:3072 nt
    s_nop 1
    v_add_f32_dpp v24, v24, v24 row_mirror row_mask:0xf bank_mask:0x3
    v_add_f32_dpp v25, v25, v25 row_mirror row_mask:0xf bank_mask:0x3
    v_add_f32_dpp v24, v26, v26 row_mirror row_mask:0xf bank_mask:0xc
    v_add_f32_dpp v25, v27, v27 row_mirror row_mask:0xf bank_mask:0xc
    s_nop 0
    v_add_f32_dpp v35, v24, v24 row_half_mirror row_mask:0xf bank_mask:0x5
    v_add_f32_dpp v35, v25, v25 row_half_mirror row_mask:0xf bank_mask:0xa
    v_cndmask_b32 v24, v33, v32, s[52:53]
    v_cndmask_b32 v25, v35, v34, s[52:53]
    v_cndmask_b32 v26, v32, v33, s[52:53]
    v_cndmask_b32 v27, v34, v35, s[52:53]
    s_nop 0
    v_add_f32_dpp v26, v24, v26 quad_perm:[1,0,3,2] row_mask:0xf bank_mask:0xf
    v_add_f32_dpp v27, v25, v27 quad_perm:[1,0,3,2] row_mask:0xf bank_mask:0xf
    v_cndmask_b32 v24, v27, v26, s[54:55]
    v_cndmask_b32 v25, v26, v27, s[54:55]
    s_nop 1
    v_add_f32_dpp v39, v24, v25 quad_perm:[2,3,0,1] row_mask:0xf bank_mask:0xf
    s_branch L_kdone
L_vb0:
    v_and_b32_dpp v16, v42, v8 row_newbcast:0 row_mask:0xf bank_mask:0xf
    v_and_b32_dpp v17, v42, v9 row_newbcast:0 row_mask:0xf bank_mask:0xf
    v_and_b32_dpp v18, v42, v10 row_newbcast:0 row_mask:0xf bank_mask:0xf
    v_and_b32_dpp v19, v42, v11 row_newbcast:0 row_mask:0xf bank_mask:0xf
    s_waitcnt vmcnt(18)
    s_nop 0
    v_mfma_f32_16x16x32_bf16 v[12:15], v[16:19], v[84:87], v[12:15]
    buffer_load_dwordx4 v[84:87], v2, s[32:35], s37 offen nt
    v_and_b32_dpp v20, v42, v8 row_newbcast:4 row_mask:0xf bank_mask:0xf
    v_and_b32_dpp v21, v42, v9 row_newbcast:4 row_mask:0xf bank_mask:0xf
    v_and_b32_dpp v22, v42, v10 row_newbcast:4 row_mask:0xf bank_mask:0xf
    v_and_b32_dpp v23, v42, v11 row_newbcast:4 row_mask:0xf bank_mask:0xf
    s_waitcnt vmcnt(18)
    s_nop 0
    v_mfma_f32_16x16x32_bf16 v[12:15], v[20:23], v[88:91], v[12:15]
    buffer_load_dwordx4 v[88:91], v2, s[32:35], s37 offen offset:1024 nt
    v_and_b32_dpp v16, v42, v8 row_newbcast:8 row_mask:0xf bank_mask:0xf
    v_and_b32_dpp v17, v42, v9 row_newbcast:8 row_mask:0xf bank_mask:0xf
    v_and_b32_dpp v18, v42, v10 row_newbcast:8 row_mask:0xf bank_mask:0xf
    v_and_b32_dpp v19, v42, v11 row_newbcast:8 row_mask:0xf bank_mask:0xf
    s_waitcnt vmcnt(18)
    s_nop 0
    v_mfma_f32_16x16x32_bf16 v[12:15], v[16:19], v[92:95], v[12:15]
    buffer_load_dwordx4 v[92:95], v2, s[32:35], s37 offen offset:2048 nt
    v_and_b32_dpp v20, v42, v8 row_newbcast:12 row_mask:0xf bank_mask:0xf
    v_and_b32_dpp v21, v42, v9 row_newbcast:12 row_mask:0xf bank_mask:0xf
    v_and_b32_dpp v22, v42, v10 row_newbcast:12 row_mask:0xf bank_mask:0xf
    v_and_b32_dpp v23, v42, v11 row_newbcast:12 row_mask:0xf bank_mask:0xf
    s_waitcnt vmcnt(18)
    s_nop 0
    v_mfma_f32_16x16x32_bf16 v[12:15], v[20:23], v[96:99], v[12:15]
    buffer_load_dwordx4 v[96:99], v2, s[32:35], s37 offen offset:3072 nt
    v_and_b32_dpp v16, v42, v8 row_newbcast:1 row_mask:0xf bank_mask:0xf
    v_and_b32_dpp v17, v42, v9 row_newbcast:1 row_mask:0xf bank_mask:0xf
    v_and_b32_dpp v18, v42, v10 row_newbcast:1 row_mask:0xf bank_mask:0xf
    v_and_b32_dpp v19, v42, v11 row_newbcast:1 row_mask:0xf bank_mask:0xf
    s_waitcnt vmcnt(18)
    s_nop 0
    v_mfma_f32_16x16x32_bf16 v[12:15], v[16:19], v[100:103], v[12:15]
    s_add_u32 s44, s37, 4096
    buffer_load_dwordx4 v[100:103], v2, s[32:35], s44 offen nt
    v_and_b32_dpp v20, v42, v8 row_newbcast:5 row_mask:0xf bank_mask:0xf
    v_and_b32_dpp v21, v42, v9 row_newbcast:5 row_mask:0xf bank_mask:0xf
    v_and_b32_dpp v22, v42, v10 row_newbcast:5 row_mask:0xf bank_mask:0xf
    v_and_b32_dpp v23, v42, v11 row_newbcast:5 row_mask:0xf bank_mask:0xf
    s_waitcnt vmcnt(18)
    s_nop 0
    v_mfma_f32_16x16x32_bf16 v[12:15], v[20:23], v[104:107], v[12:15]
    buffer_load_dwordx4 v[104:107], v2, s[32:35], s44 offen offset:1024 nt
    v_and_b32_dpp v16, v42, v8 row_newbcast:9 row_mask:0xf bank_mask:0xf
    v_and_b32_dpp v17, v42, v9 row_newbcast:9 row_mask:0xf bank_mask:0xf
    v_and_b32_dpp v18, v42, v10 row_newbcast:9 row_mask:0xf bank_mask:0xf
    v_and_b32_dpp v19, v42, v11 row_newbcast:9 row_mask:0xf bank_mask:0xf
    s_waitcnt vmcnt(18)
    s_nop 0
    v_mfma_f32_16x16x32_bf16 v[12:15], v[16:19], v[108:111], v[12:15]
    buffer_load_dwordx4 v[108:111], v2, s[32:35], s44 offen offset:2048 nt
    v_and_b32_dpp v20, v42, v8 row_newbcast:13 row_mask:0xf bank_mask:0xf
    v_and_b32_dpp v21, v42, v9 row_newbcast:13 row_mask:0xf bank_mask:0xf
    v_and_b32_dpp v22, v42, v10 row_newbcast:13 row_mask:0xf bank_mask:0xf
    v_and_b32_dpp v23, v42, v11 row_newbcast:13 row_mask:0xf bank_mask:0xf
    s_waitcnt vmcnt(18)
    s_nop 0
    v_mfma_f32_16x16x32_bf16 v[12:15], v[20:23], v[112:115], v[12:15]
    buffer_load_dwordx4 v[112:115], v2, s[32:35], s44 offen offset:3072 nt
    v_and_b32_dpp v16, v42, v8 row_newbcast:2 row_mask:0xf bank_mask:0xf
    v_and_b32_dpp v17, v42, v9 row_newbcast:2 row_mask:0xf bank_mask:0xf
    v_and_b32_dpp v18, v42, v10 row_newbcast:2 row_mask:0xf bank_mask:0xf
    v_and_b32_dpp v19, v42, v11 row_newbcast:2 row_mask:0xf bank_mask:0xf
    s_waitcnt vmcnt(18)
    s_nop 0
    v_mfma_f32_16x16x32_bf16 v[12:15], v[16:19], v[116:119], v[12:15]
    s_add_u32 s44, s37, 8192
    buffer_load_dwordx4 v[116:119], v2, s[32:35], s44 offen nt
    v_and_b32_dpp v20, v42, v8 row_newbcast:6 row_mask:0xf bank_mask:0xf
    v_and_b32_dpp v21, v42, v9 row_newbcast:6 row_mask:0xf bank_mask:0xf
    v_and_b32_dpp v22, v42, v10 row_newbcast:6 row_mask:0xf bank_mask:0xf
    v_and_b32_dpp v23, v42, v11 row_newbcast:6 row_mask:0xf bank_mask:0xf
    s_waitcnt vmcnt(18)
    s_nop 0
    v_mfma_f32_16x16x32_bf16 v[12:15], v[20:23], v[120:123], v[12:15]
    buffer_load_dwordx4 v[120:123], v2, s[32:35], s44 offen offset:1024 nt
    v_and_b32_dpp v16, v42, v8 row_newbcast:10 row_mask:0xf bank_mask:0xf
    v_and_b32_dpp v17, v42, v9 row_newbcast:10 row_mask:0xf bank_mask:0xf
    v_and_b32_dpp v18, v42, v10 row_newbcast:10 row_mask:0xf bank_mask:0xf
    v_and_b32_dpp v19, v42, v11 row_newbcast:10 row_mask:0xf bank_mask:0xf
    s_waitcnt vmcnt(18)
    s_nop 0
    v_mfma_f32_16x16x32_bf16 v[12:15], v[16:19], v[124:127], v[12:15]
    buffer_load_dwordx4 v[124:127], v2, s[32:35], s44 offen offset:2048 nt
    v_and_b32_dpp v20, v42, v8 row_newbcast:14 row_mask:0xf bank_mask:0xf
    v_and_b32_dpp v21, v42, v9 row_newbcast:14 row_mask:0xf bank_mask:0xf
    v_and_b32_dpp v22, v42, v10 row_newbcast:14 row_mask:0xf bank_mask:0xf
    v_and_b32_dpp v23, v42, v11 row_newbcast:14 row_mask:0xf bank_mask:0xf
    s_waitcnt vmcnt(18)
    s_nop 0
    v_mfma_f32_16x16x32_bf16 v[12:15], v[20:23], v[128:131], v[12:15]
    buffer_load_dwordx4 v[128:131], v2, s[32:35], s44 offen offset:3072 nt
    v_and_b32_dpp v16, v42, v8 row_newbcast:3 row_mask:0xf bank_mask:0xf
    v_and_b32_dpp v17, v42, v9 row_newbcast:3 row_mask:0xf bank_mask:0xf
    v_and_b32_dpp v18, v42, v10 row_newbcast:3 row_mask:0xf bank_mask:0xf
    v_and_b32_dpp v19, v42, v11 row_newbcast:3 row_mask:0xf bank_mask:0xf
    s_waitcnt vmcnt(18)
    s_nop 0
    v_mfma_f32_16x16x32_bf16 v[12:15], v[16:19], v[132:135], v[12:15]
    s_add_u32 s44, s37, 12288
    buffer_load_dwordx4 v[132:135], v2, s[32:35], s44 offen nt
    v_and_b32_dpp v20, v42, v8 row_newbcast:7 row_mask:0xf bank_mask:0xf
    v_and_b32_dpp v21, v42, v9 row_newbcast:7 row_mask:0xf bank_mask:0xf
    v_and_b32_dpp v22, v42, v10 row_newbcast:7 row_mask:0xf bank_mask:0xf
    v_and_b32_dpp v23, v42, v11 row_newbcast:7 row_mask:0xf bank_mask:0xf
    s_waitcnt vmcnt(18)
    s_nop 0
    v_mfma_f32_16x16x32_bf16 v[12:15], v[20:23], v[136:139], v[12:15]
    buffer_load_dwordx4 v[136:139], v2, s[32:35], s44 offen offset:1024 nt
    v_and_b32_dpp v16, v42, v8 row_newbcast:11 row_mask:0xf bank_mask:0xf
    v_and_b32_dpp v17, v42, v9 row_newbcast:11 row_mask:0xf bank_mask:0xf
    v_and_b32_dpp v18, v42, v10 row_newbcast:11 row_mask:0xf bank_mask:0xf
    v_and_b32_dpp v19, v42, v11 row_newbcast:11 row_mask:0xf bank_mask:0xf
    s_waitcnt vmcnt(18)
    s_nop 0
    v_mfma_f32_16x16x32_bf16 v[12:15], v[16:19], v[140:143], v[12:15]
    buffer_load_dwordx4 v[140:143], v2, s[32:35], s44 offen offset:2048 nt
    v_and_b32_dpp v20, v42, v8 row_newbcast:15 row_mask:0xf bank_mask:0xf
    v_and_b32_dpp v21, v42, v9 row_newbcast:15 row_mask:0xf bank_mask:0xf
    v_and_b32_dpp v22, v42, v10 row_newbcast:15 row_mask:0xf bank_mask:0xf
    v_and_b32_dpp v23, v42, v11 row_newbcast:15 row_mask:0xf bank_mask:0xf
    s_waitcnt vmcnt(18)
    s_nop 0
    v_mfma_f32_16x16x32_bf16 v[12:15], v[20:23], v[144:147], v[12:15]
    buffer_load_dwordx4 v[144:147], v2, s[32:35], s44 offen offset:3072 nt
    v_and_b32_dpp v16, v43, v8 row_newbcast:0 row_mask:0xf bank_mask:0xf
    v_and_b32_dpp v17, v43, v9 row_newbcast:0 row_mask:0xf bank_mask:0xf
    v_and_b32_dpp v18, v43, v10 row_newbcast:0 row_mask:0xf bank_mask:0xf
    v_and_b32_dpp v19, v43, v11 row_newbcast:0 row_mask:0xf bank_mask:0xf
    s_waitcnt vmcnt(18)
    s_nop 0
    v_mfma_f32_16x16x32_bf16 v[12:15], v[16:19], v[148:151], v[12:15]
    s_add_u32 s44, s37, 16384
    buffer_load_dwordx4 v[148:151], v2, s[32:35], s44 offen nt
    v_and_b32_dpp v20, v43, v8 row_newbcast:4 row_mask:0xf bank_mask:0xf
    v_and_b32_dpp v21, v43, v9 row_newbcast:4 row_mask:0xf bank_mask:0xf
    v_and_b32_dpp v22, v43, v10 row_newbcast:4 row_mask:0xf bank_mask:0xf
    v_and_b32_dpp v23, v43, v11 row_newbcast:4 row_mask:0xf bank_mask:0xf
    s_waitcnt vmcnt(18)
    s_nop 0
    v_mfma_f32_16x16x32_bf16 v[12:15], v[20:23], v[152:155], v[12:15]
    buffer_load_dwordx4 v[152:155], v2, s[32:35], s44 offen offset:1024 nt
    v_and_b32_dpp v16, v43, v8 row_newbcast:8 row_mask:0xf bank_mask:0xf
    v_and_b32_dpp v17, v43, v9 row_newbcast:8 row_mask:0xf bank_mask:0xf
    v_and_b32_dpp v18, v43, v10 row_newbcast:8 row_mask:0xf bank_mask:0xf
    v_and_b32_dpp v19, v43, v11 row_newbcast:8 row_mask:0xf bank_mask:0xf
    s_waitcnt vmcnt(18)
    s_nop 0
    v_mfma_f32_16x16x32_bf16 v[12:15], v[16:19], v[156:159], v[12:15]
    buffer_load_dwordx4 v[156:159], v2, s[32:35], s44 offen offset:2048 nt
    v_and_b32_dpp v20, v43, v8 row_newbcast:12 row_mask:0xf bank_mask:0xf
    v_and_b32_dpp v21, v43, v9 row_newbcast:12 row_mask:0xf bank_mask:0xf
    v_and_b32_dpp v22, v43, v10 row_newbcast:12 row_mask:0xf bank_mask:0xf
    v_and_b32_dpp v23, v43, v11 row_newbcast:12 row_mask:0xf bank_mask:0xf
    s_waitcnt vmcnt(18)
    s_nop 0
    v_mfma_f32_16x16x32_bf16 v[12:15], v[20:23], v[160:163], v[12:15]
    buffer_load_dwordx4 v[160:163], v2, s[32:35], s44 offen offset:3072 nt
    v_and_b32_dpp v16, v43, v8 row_newbcast:1 row_mask:0xf bank_mask:0xf
    v_and_b32_dpp v17, v43, v9 row_newbcast:1 row_mask:0xf bank_mask:0xf
    v_and_b32_dpp v18, v43, v10 row_newbcast:1 row_mask:0xf bank_mask:0xf
    v_and_b32_dpp v19, v43, v11 row_newbcast:1 row_mask:0xf bank_mask:0xf
    s_waitcnt vmcnt(18)
    s_nop 0
    v_mfma_f32_16x16x32_bf16 v[12:15], v[16:19], v[164:167], v[12:15]
    s_add_u32 s44, s37, 20480
    buffer_load_dwordx4 v[164:167], v2, s[32:35], s44 offen nt
    v_and_b32_dpp v20, v43, v8 row_newbcast:5 row_mask:0xf bank_mask:0xf
    v_and_b32_dpp v21, v43, v9 row_newbcast:5 row_mask:0xf bank_mask:0xf
    v_and_b32_dpp v22, v43, v10 row_newbcast:5 row_mask:0xf bank_mask:0xf
    v_and_b32_dpp v23, v43, v11 row_newbcast:5 row_mask:0xf bank_mask:0xf
    s_waitcnt vmcnt(18)
    s_nop 0
    v_mfma_f32_16x16x32_bf16 v[12:15], v[20:23], v[168:171], v[12:15]
    buffer_load_dwordx4 v[168:171], v2, s[32:35], s44 offen offset:1024 nt
    v_and_b32_dpp v16, v43, v8 row_newbcast:9 row_mask:0xf bank_mask:0xf
    v_and_b32_dpp v17, v43, v9 row_newbcast:9 row_mask:0xf bank_mask:0xf
    v_and_b32_dpp v18, v43, v10 row_newbcast:9 row_mask:0xf bank_mask:0xf
    v_and_b32_dpp v19, v43, v11 row_newbcast:9 row_mask:0xf bank_mask:0xf
    s_waitcnt vmcnt(18)
    s_nop 0
    v_mfma_f32_16x16x32_bf16 v[12:15], v[16:19], v[172:175], v[12:15]
    buffer_load_dwordx4 v[172:175], v2, s[32:35], s44 offen offset:2048 nt
    v_and_b32_dpp v20, v43, v8 row_newbcast:13 row_mask:0xf bank_mask:0xf
    v_and_b32_dpp v21, v43, v9 row_newbcast:13 row_mask:0xf bank_mask:0xf
    v_and_b32_dpp v22, v43, v10 row_newbcast:13 row_mask:0xf bank_mask:0xf
    v_and_b32_dpp v23, v43, v11 row_newbcast:13 row_mask:0xf bank_mask:0xf
    s_waitcnt vmcnt(18)
    s_nop 0
    v_mfma_f32_16x16x32_bf16 v[12:15], v[20:23], v[176:179], v[12:15]
    buffer_load_dwordx4 v[176:179], v2, s[32:35], s44 offen offset:3072 nt
    v_and_b32_dpp v16, v43, v8 row_newbcast:2 row_mask:0xf bank_mask:0xf
    v_and_b32_dpp v17, v43, v9 row_newbcast:2 row_mask:0xf bank_mask:0xf
    v_and_b32_dpp v18, v43, v10 row_newbcast:2 row_mask:0xf bank_mask:0xf
    v_and_b32_dpp v19, v43, v11 row_newbcast:2 row_mask:0xf bank_mask:0xf
    s_waitcnt vmcnt(18)
    s_nop 0
    v_mfma_f32_16x16x32_bf16 v[12:15], v[16:19], v[180:183], v[12:15]
    s_add_u32 s44, s37, 24576
    buffer_load_dwordx4 v[180:183], v2, s[32:35], s44 offen nt
    v_and_b32_dpp v20, v43, v8 row_newbcast:6 row_mask:0xf bank_mask:0xf
    v_and_b32_dpp v21, v43, v9 row_newbcast:6 row_mask:0xf bank_mask:0xf
    v_and_b32_dpp v22, v43, v10 row_newbcast:6 row_mask:0xf bank_mask:0xf
    v_and_b32_dpp v23, v43, v11 row_newbcast:6 row_mask:0xf bank_mask:0xf
    s_waitcnt vmcnt(18)
    s_nop 0
    v_mfma_f32_16x16x32_bf16 v[12:15], v[20:23], v[184:187], v[12:15]
    buffer_load_dwordx4 v[184:187], v2, s[32:35], s44 offen offset:1024 nt
    v_and_b32_dpp v16, v43, v8 row_newbcast:10 row_mask:0xf bank_mask:0xf
    v_and_b32_dpp v17, v43, v9 row_newbcast:10 row_mask:0xf bank_mask:0xf
    v_and_b32_dpp v18, v43, v10 row_newbcast:10 row_mask:0xf bank_mask:0xf
    v_and_b32_dpp v19, v43, v11 row_newbcast:10 row_mask:0xf bank_mask:0xf
    s_waitcnt vmcnt(18)
    s_nop 0
    v_mfma_f32_16x16x32_bf16 v[12:15], v[16:19], v[188:191], v[12:15]
    buffer_load_dwordx4 v[188:191], v2, s[32:35], s44 offen offset:2048 nt
    v_and_b32_dpp v20, v43, v8 row_newbcast:14 row_mask:0xf bank_mask:0xf
    v_and_b32_dpp v21, v43, v9 row_newbcast:14 row_mask:0xf bank_mask:0xf
    v_and_b32_dpp v22, v43, v10 row_newbcast:14 row_mask:0xf bank_mask:0xf
    v_and_b32_dpp v23, v43, v11 row_newbcast:14 row_mask:0xf bank_mask:0xf
    s_waitcnt vmcnt(18)
    s_nop 0
    v_mfma_f32_16x16x32_bf16 v[12:15], v[20:23], v[192:195], v[12:15]
    buffer_load_dwordx4 v[192:195], v2, s[32:35], s44 offen offset:3072 nt
    v_and_b32_dpp v16, v43, v8 row_newbcast:3 row_mask:0xf bank_mask:0xf
    v_and_b32_dpp v17, v43, v9 row_newbcast:3 row_mask:0xf bank_mask:0xf
    v_and_b32_dpp v18, v43, v10 row_newbcast:3 row_mask:0xf bank_mask:0xf
    v_and_b32_dpp v19, v43, v11 row_newbcast:3 row_mask:0xf bank_mask:0xf
    s_waitcnt vmcnt(18)
    s_nop 0
    v_mfma_f32_16x16x32_bf16 v[12:15], v[16:19], v[196:199], v[12:15]
    s_add_u32 s44, s37, 28672
    buffer_load_dwordx4 v[196:199], v2, s[32:35], s44 offen nt
    v_and_b32_dpp v20, v43, v8 row_newbcast:7 row_mask:0xf bank_mask:0xf
    v_and_b32_dpp v21, v43, v9 row_newbcast:7 row_mask:0xf bank_mask:0xf
    v_and_b32_dpp v22, v43, v10 row_newbcast:7 row_mask:0xf bank_mask:0xf
    v_and_b32_dpp v23, v43, v11 row_newbcast:7 row_mask:0xf bank_mask:0xf
    s_waitcnt vmcnt(18)
    s_nop 0
    v_mfma_f32_16x16x32_bf16 v[12:15], v[20:23], v[200:203], v[12:15]
    buffer_load_dwordx4 v[200:203], v2, s[32:35], s44 offen offset:1024 nt
    v_and_b32_dpp v16, v43, v8 row_newbcast:11 row_mask:0xf bank_mask:0xf
    v_and_b32_dpp v17, v43, v9 row_newbcast:11 row_mask:0xf bank_mask:0xf
    v_and_b32_dpp v18, v43, v10 row_newbcast:11 row_mask:0xf bank_mask:0xf
    v_and_b32_dpp v19, v43, v11 row_newbcast:11 row_mask:0xf bank_mask:0xf
    s_waitcnt vmcnt(18)
    s_nop 0
    v_mfma_f32_16x16x32_bf16 v[12:15], v[16:19], v[204:207], v[12:15]
    buffer_load_dwordx4 v[204:207], v2, s[32:35], s44 offen offset:2048 nt
    v_and_b32_dpp v20, v43, v8 row_newbcast:15 row_mask:0xf bank_mask:0xf
    v_and_b32_dpp v21, v43, v9 row_newbcast:15 row_mask:0xf bank_mask:0xf
    v_and_b32_dpp v22, v43, v10 row_newbcast:15 row_mask:0xf bank_mask:0xf
    v_and_b32_dpp v23, v43, v11 row_newbcast:15 row_mask:0xf bank_mask:0xf
    s_waitcnt vmcnt(18)
    s_nop 0
    v_mfma_f32_16x16x32_bf16 v[12:15], v[20:23], v[208:211], v[12:15]
    buffer_load_dwordx4 v[208:211], v2, s[32:35], s44 offen offset:3072 nt
    s_branch L_vdone
L_vb2:
    v_and_b32_dpp v16, v42, v8 row_newbcast:0 row_mask:0xf bank_mask:0xf
    v_and_b32_dpp v17, v42, v9 row_newbcast:0 row_mask:0xf bank_mask:0xf
    v_and_b32_dpp v18, v42, v10 row_newbcast:0 row_mask:0xf bank_mask:0xf
    v_and_b32_dpp v19, v42, v11 row_newbcast:0 row_mask:0xf bank_mask:0xf
    s_waitcnt vmcnt(20)
    s_nop 0
    v_mfma_f32_16x16x32_bf16 v[12:15], v[16:19], v[84:87], v[12:15]
    buffer_load_dwordx4 v[84:87], v2, s[32:35], s37 offen nt
    v_and_b32_dpp v20, v42, v8 row_newbcast:4 row_mask:0xf bank_mask:0xf
    v_and_b32_dpp v21, v42, v9 row_newbcast:4 row_mask:0xf bank_mask:0xf
    v_and_b32_dpp v22, v42, v10 row_newbcast:4 row_mask:0xf bank_mask:0xf
    v_and_b32_dpp v23, v42, v11 row_newbcast:4 row_mask:0xf bank_mask:0xf
    s_waitcnt vmcnt(20)
    s_nop 0
    v_mfma_f32_16x16x32_bf16 v[12:15], v[20:23], v[88:91], v[12:15]
    buffer_load_dwordx4 v[88:91], v2, s[32:35], s37 offen offset:1024 nt
    v_and_b32_dpp v16, v42, v8 row_newbcast:8 row_mask:0xf bank_mask:0xf
    v_and_b32_dpp v17, v42, v9 row_newbcast:8 row_mask:0xf bank_mask:0xf
    v_and_b32_dpp v18, v42, v10 row_newbcast:8 row_mask:0xf bank_mask:0xf
    v_and_b32_dpp v19, v42, v11 row_newbcast:8 row_mask:0xf bank_mask:0xf
    s_waitcnt vmcnt(20)
    s_nop 0
    v_mfma_f32_16x16x32_bf16 v[12:15], v[16:19], v[92:95], v[12:15]
    buffer_load_dwordx4 v[92:95], v2, s[32:35], s37 offen offset:2048 nt
    v_and_b32_dpp v20, v42, v8 row_newbcast:12 row_mask:0xf bank_mask:0xf
    v_and_b32_dpp v21, v42, v9 row_newbcast:12 row_mask:0xf bank_mask:0xf
    v_and_b32_dpp v22, v42, v10 row_newbcast:12 row_mask:0xf bank_mask:0xf
    v_and_b32_dpp v23, v42, v11 row_newbcast:12 row_mask:0xf bank_mask:0xf
    s_waitcnt vmcnt(20)
    s_nop 0
    v_mfma_f32_16x16x32_bf16 v[12:15], v[20:23], v[96:99], v[12:15]
    buffer_load_dwordx4 v[96:99], v2, s[32:35], s37 offen offset:3072 nt
    v_and_b32_dpp v16, v42, v8 row_newbcast:1 row_mask:0xf bank_mask:0xf
    v_and_b32_dpp v17, v42, v9 row_newbcast:1 row_mask:0xf bank_mask:0xf
    v_and_b32_dpp v18, v42, v10 row_newbcast:1 row_mask:0xf bank_mask:0xf
    v_and_b32_dpp v19, v42, v11 row_newbcast:1 row_mask:0xf bank_mask:0xf
    s_waitcnt vmcnt(20)
    s_nop 0
    v_mfma_f32_16x16x32_bf16 v[12:15], v[16:19], v[100:103], v[12:15]
    s_add_u32 s44, s37, 4096
    buffer_load_dwordx4 v[100:103], v2, s[32:35], s44 offen nt
    v_and_b32_dpp v20, v42, v8 row_newbcast:5 row_mask:0xf bank_mask:0xf
    v_and_b32_dpp v21, v42, v9 row_newbcast:5 row_mask:0xf bank_mask:0xf
    v_and_b32_dpp v22, v42, v10 row_newbcast:5 row_mask:0xf bank_mask:0xf
    v_and_b32_dpp v23, v42, v11 row_newbcast:5 row_mask:0xf bank_mask:0xf
    s_waitcnt vmcnt(20)
    s_nop 0
    v_mfma_f32_16x16x32_bf16 v[12:15], v[20:23], v[104:107], v[12:15]
    buffer_load_dwordx4 v[104:107], v2, s[32:35], s44 offen offset:1024 nt
    v_and_b32_dpp v16, v42, v8 row_newbcast:9 row_mask:0xf bank_mask:0xf
    v_and_b32_dpp v17, v42, v9 row_newbcast:9 row_mask:0xf bank_mask:0xf
    v_and_b32_dpp v18, v42, v10 row_newbcast:9 row_mask:0xf bank_mask:0xf
    v_and_b32_dpp v19, v42, v11 row_newbcast:9 row_mask:0xf bank_mask:0xf
    s_waitcnt vmcnt(20)
    s_nop 0
    v_mfma_f32_16x16x32_bf16 v[12:15], v[16:19], v[108:111], v[12:15]
    buffer_load_dwordx4 v[108:111], v2, s[32:35], s44 offen offset:2048 nt
    v_and_b32_dpp v20, v42, v8 row_newbcast:13 row_mask:0xf bank_mask:0xf
    v_and_b32_dpp v21, v42, v9 row_newbcast:13 row_mask:0xf bank_mask:0xf
    v_and_b32_dpp v22, v42, v10 row_newbcast:13 row_mask:0xf bank_mask:0xf
    v_and_b32_dpp v23, v42, v11 row_newbcast:13 row_mask:0xf bank_mask:0xf
    s_waitcnt vmcnt(20)
    s_nop 0
    v_mfma_f32_16x16x32_bf16 v[12:15], v[20:23], v[112:115], v[12:15]
    buffer_load_dwordx4 v[112:115], v2, s[32:35], s44 offen offset:3072 nt
    v_and_b32_dpp v16, v42, v8 row_newbcast:2 row_mask:0xf bank_mask:0xf
    v_and_b32_dpp v17, v42, v9 row_newbcast:2 row_mask:0xf bank_mask:0xf
    v_and_b32_dpp v18, v42, v10 row_newbcast:2 row_mask:0xf bank_mask:0xf
    v_and_b32_dpp v19, v42, v11 row_newbcast:2 row_mask:0xf bank_mask:0xf
    s_waitcnt vmcnt(20)
    s_nop 0
    v_mfma_f32_16x16x32_bf16 v[12:15], v[16:19], v[116:119], v[12:15]
    s_add_u32 s44, s37, 8192
    buffer_load_dwordx4 v[116:119], v2, s[32:35], s44 offen nt
    v_and_b32_dpp v20, v42, v8 row_newbcast:6 row_mask:0xf bank_mask:0xf
    v_and_b32_dpp v21, v42, v9 row_newbcast:6 row_mask:0xf bank_mask:0xf
    v_and_b32_dpp v22, v42, v10 row_newbcast:6 row_mask:0xf bank_mask:0xf
    v_and_b32_dpp v23, v42, v11 row_newbcast:6 row_mask:0xf bank_mask:0xf
    s_waitcnt vmcnt(20)
    s_nop 0
    v_mfma_f32_16x16x32_bf16 v[12:15], v[20:23], v[120:123], v[12:15]
    buffer_load_dwordx4 v[120:123], v2, s[32:35], s44 offen offset:1024 nt
    v_and_b32_dpp v16, v42, v8 row_newbcast:10 row_mask:0xf bank_mask:0xf
    v_and_b32_dpp v17, v42, v9 row_newbcast:10 row_mask:0xf bank_mask:0xf
    v_and_b32_dpp v18, v42, v10 row_newbcast:10 row_mask:0xf bank_mask:0xf
    v_and_b32_dpp v19, v42, v11 row_newbcast:10 row_mask:0xf bank_mask:0xf
    s_waitcnt vmcnt(20)
    s_nop 0
    v_mfma_f32_16x16x32_bf16 v[12:15], v[16:19], v[124:127], v[12:15]
    buffer_load_dwordx4 v[124:127], v2, s[32:35], s44 offen offset:2048 nt
    v_and_b32_dpp v20, v42, v8 row_newbcast:14 row_mask:0xf bank_mask:0xf
    v_and_b32_dpp v21, v42, v9 row_newbcast:14 row_mask:0xf bank_mask:0xf
    v_and_b32_dpp v22, v42, v10 row_newbcast:14 row_mask:0xf bank_mask:0xf
    v_and_b32_dpp v23, v42, v11 row_newbcast:14 row_mask:0xf bank_mask:0xf
    s_waitcnt vmcnt(20)
    s_nop 0
    v_mfma_f32_16x16x32_bf16 v[12:15], v[20:23], v[128:131], v[12:15]
    buffer_load_dwordx4 v[128:131], v2, s[32:35], s44 offen offset:3072 nt
    v_and_b32_dpp v16, v42, v8 row_newbcast:3 row_mask:0xf bank_mask:0xf
    v_and_b32_dpp v17, v42, v9 row_newbcast:3 row_mask:0xf bank_mask:0xf
    v_and_b32_dpp v18, v42, v10 row_newbcast:3 row_mask:0xf bank_mask:0xf
    v_and_b32_dpp v19, v42, v11 row_newbcast:3 row_mask:0xf bank_mask:0xf
    s_waitcnt vmcnt(20)
    s_nop 0
    v_mfma_f32_16x16x32_bf16 v[12:15], v[16:19], v[132:135], v[12:15]
    s_add_u32 s44, s37, 12288
    buffer_load_dwordx4 v[132:135], v2, s[32:35], s44 offen nt
    v_and_b32_dpp v20, v42, v8 row_newbcast:7 row_mask:0xf bank_mask:0xf
    v_and_b32_dpp v21, v42, v9 row_newbcast:7 row_mask:0xf bank_mask:0xf
    v_and_b32_dpp v22, v42, v10 row_newbcast:7 row_mask:0xf bank_mask:0xf
    v_and_b32_dpp v23, v42, v11 row_newbcast:7 row_mask:0xf bank_mask:0xf
    s_waitcnt vmcnt(20)
    s_nop 0
    v_mfma_f32_16x16x32_bf16 v[12:15], v[20:23], v[136:139], v[12:15]
    buffer_load_dwordx4 v[136:139], v2, s[32:35], s44 offen offset:1024 nt
    v_and_b32_dpp v16, v42, v8 row_newbcast:11 row_mask:0xf bank_mask:0xf
    v_and_b32_dpp v17, v42, v9 row_newbcast:11 row_mask:0xf bank_mask:0xf
    v_and_b32_dpp v18, v42, v10 row_newbcast:11 row_mask:0xf bank_mask:0xf
    v_and_b32_dpp v19, v42, v11 row_newbcast:11 row_mask:0xf bank_mask:0xf
    s_waitcnt vmcnt(20)
    s_nop 0
    v_mfma_f32_16x16x32_bf16 v[12:15], v[16:19], v[140:143], v[12:15]
    buffer_load_dwordx4 v[140:143], v2, s[32:35], s44 offen offset:2048 nt
    v_and_b32_dpp v20, v42, v8 row_newbcast:15 row_mask:0xf bank_mask:0xf
    v_and_b32_dpp v21, v42, v9 row_newbcast:15 row_mask:0xf bank_mask:0xf
    v_and_b32_dpp v22, v42, v10 row_newbcast:15 row_mask:0xf bank_mask:0xf
    v_and_b32_dpp v23, v42, v11 row_newbcast:15 row_mask:0xf bank_mask:0xf
    s_waitcnt vmcnt(20)
    s_nop 0
    v_mfma_f32_16x16x32_bf16 v[12:15], v[20:23], v[144:147], v[12:15]
    buffer_load_dwordx4 v[144:147], v2, s[32:35], s44 offen offset:3072 nt
    v_and_b32_dpp v16, v43, v8 row_newbcast:0 row_mask:0xf bank_mask:0xf
    v_and_b32_dpp v17, v43, v9 row_newbcast:0 row_mask:0xf bank_mask:0xf
    v_and_b32_dpp v18, v43, v10 row_newbcast:0 row_mask:0xf bank_mask:0xf
    v_and_b32_dpp v19, v43, v11 row_newbcast:0 row_mask:0xf bank_mask:0xf
    s_waitcnt vmcnt(20)
    s_nop 0
    v_mfma_f32_16x16x32_bf16 v[12:15], v[16:19], v[148:151], v[12:15]
    s_add_u32 s44, s37, 16384
    buffer_load_dwordx4 v[148:151], v2, s[32:35], s44 offen nt
    v_and_b32_dpp v20, v43, v8 row_newbcast:4 row_mask:0xf bank_mask:0xf
    v_and_b32_dpp v21, v43, v9 row_newbcast:4 row_mask:0xf bank_mask:0xf
    v_and_b32_dpp v22, v43, v10 row_newbcast:4 row_mask:0xf bank_mask:0xf
    v_and_b32_dpp v23, v43, v11 row_newbcast:4 row_mask:0xf bank_mask:0xf
    s_waitcnt vmcnt(20)
    s_nop 0
    v_mfma_f32_16x16x32_bf16 v[12:15], v[20:23], v[152:155], v[12:15]
    buffer_load_dwordx4 v[152:155], v2, s[32:35], s44 offen offset:1024 nt
    v_and_b32_dpp v16, v43, v8 row_newbcast:8 row_mask:0xf bank_mask:0xf
    v_and_b32_dpp v17, v43, v9 row_newbcast:8 row_mask:0xf bank_mask:0xf
    v_and_b32_dpp v18, v43, v10 row_newbcast:8 row_mask:0xf bank_mask:0xf
    v_and_b32_dpp v19, v43, v11 row_newbcast:8 row_mask:0xf bank_mask:0xf
    s_waitcnt vmcnt(20)
    s_nop 0
    v_mfma_f32_16x16x32_bf16 v[12:15], v[16:19], v[156:159], v[12:15]
    buffer_load_dwordx4 v[156:159], v2, s[32:35], s44 offen offset:2048 nt
    v_and_b32_dpp v20, v43, v8 row_newbcast:12 row_mask:0xf bank_mask:0xf
    v_and_b32_dpp v21, v43, v9 row_newbcast:12 row_mask:0xf bank_mask:0xf
    v_and_b32_dpp v22, v43, v10 row_newbcast:12 row_mask:0xf bank_mask:0xf
    v_and_b32_dpp v23, v43, v11 row_newbcast:12 row_mask:0xf bank_mask:0xf
    s_waitcnt vmcnt(20)
    s_nop 0
    v_mfma_f32_16x16x32_bf16 v[12:15], v[20:23], v[160:163], v[12:15]
    buffer_load_dwordx4 v[160:163], v2, s[32:35], s44 offen offset:3072 nt
    v_and_b32_dpp v16, v43, v8 row_newbcast:1 row_mask:0xf bank_mask:0xf
    v_and_b32_dpp v17, v43, v9 row_newbcast:1 row_mask:0xf bank_mask:0xf
    v_and_b32_dpp v18, v43, v10 row_newbcast:1 row_mask:0xf bank_mask:0xf
    v_and_b32_dpp v19, v43, v11 row_newbcast:1 row_mask:0xf bank_mask:0xf
    s_waitcnt vmcnt(20)
    s_nop 0
    v_mfma_f32_16x16x32_bf16 v[12:15], v[16:19], v[164:167], v[12:15]
    s_add_u32 s44, s37, 20480
    buffer_load_dwordx4 v[164:167], v2, s[32:35], s44 offen nt
    v_and_b32_dpp v20, v43, v8 row_newbcast:5 row_mask:0xf bank_mask:0xf
    v_and_b32_dpp v21, v43, v9 row_newbcast:5 row_mask:0xf bank_mask:0xf
    v_and_b32_dpp v22, v43, v10 row_newbcast:5 row_mask:0xf bank_mask:0xf
    v_and_b32_dpp v23, v43, v11 row_newbcast:5 row_mask:0xf bank_mask:0xf
    s_waitcnt vmcnt(20)
    s_nop 0
    v_mfma_f32_16x16x32_bf16 v[12:15], v[20:23], v[168:171], v[12:15]
    buffer_load_dwordx4 v[168:171], v2, s[32:35], s44 offen offset:1024 nt
    v_and_b32_dpp v16, v43, v8 row_newbcast:9 row_mask:0xf bank_mask:0xf
    v_and_b32_dpp v17, v43, v9 row_newbcast:9 row_mask:0xf bank_mask:0xf
    v_and_b32_dpp v18, v43, v10 row_newbcast:9 row_mask:0xf bank_mask:0xf
    v_and_b32_dpp v19, v43, v11 row_newbcast:9 row_mask:0xf bank_mask:0xf
    s_waitcnt vmcnt(20)
    s_nop 0
    v_mfma_f32_16x16x32_bf16 v[12:15], v[16:19], v[172:175], v[12:15]
    buffer_load_dwordx4 v[172:175], v2, s[32:35], s44 offen offset:2048 nt
    v_and_b32_dpp v20, v43, v8 row_newbcast:13 row_mask:0xf bank_mask:0xf
    v_and_b32_dpp v21, v43, v9 row_newbcast:13 row_mask:0xf bank_mask:0xf
    v_and_b32_dpp v22, v43, v10 row_newbcast:13 row_mask:0xf bank_mask:0xf
    v_and_b32_dpp v23, v43, v11 row_newbcast:13 row_mask:0xf bank_mask:0xf
    s_waitcnt vmcnt(20)
    s_nop 0
    v_mfma_f32_16x16x32_bf16 v[12:15], v[20:23], v[176:179], v[12:15]
    buffer_load_dwordx4 v[176:179], v2, s[32:35], s44 offen offset:3072 nt
    v_and_b32_dpp v16, v43, v8 row_newbcast:2 row_mask:0xf bank_mask:0xf
    v_and_b32_dpp v17, v43, v9 row_newbcast:2 row_mask:0xf bank_mask:0xf
    v_and_b32_dpp v18, v43, v10 row_newbcast:2 row_mask:0xf bank_mask:0xf
    v_and_b32_dpp v19, v43, v11 row_newbcast:2 row_mask:0xf bank_mask:0xf
    s_waitcnt vmcnt(20)
    s_nop 0
    v_mfma_f32_16x16x32_bf16 v[12:15], v[16:19], v[180:183], v[12:15]
    s_add_u32 s44, s37, 24576
    buffer_load_dwordx4 v[180:183], v2, s[32:35], s44 offen nt
    v_and_b32_dpp v20, v43, v8 row_newbcast:6 row_mask:0xf bank_mask:0xf
    v_and_b32_dpp v21, v43, v9 row_newbcast:6 row_mask:0xf bank_mask:0xf
    v_and_b32_dpp v22, v43, v10 row_newbcast:6 row_mask:0xf bank_mask:0xf
    v_and_b32_dpp v23, v43, v11 row_newbcast:6 row_mask:0xf bank_mask:0xf
    s_waitcnt vmcnt(20)
    s_nop 0
    v_mfma_f32_16x16x32_bf16 v[12:15], v[20:23], v[184:187], v[12:15]
    buffer_load_dwordx4 v[184:187], v2, s[32:35], s44 offen offset:1024 nt
    v_and_b32_dpp v16, v43, v8 row_newbcast:10 row_mask:0xf bank_mask:0xf
    v_and_b32_dpp v17, v43, v9 row_newbcast:10 row_mask:0xf bank_mask:0xf
    v_and_b32_dpp v18, v43, v10 row_newbcast:10 row_mask:0xf bank_mask:0xf
    v_and_b32_dpp v19, v43, v11 row_newbcast:10 row_mask:0xf bank_mask:0xf
    s_waitcnt vmcnt(20)
    s_nop 0
    v_mfma_f32_16x16x32_bf16 v[12:15], v[16:19], v[188:191], v[12:15]
    buffer_load_dwordx4 v[188:191], v2, s[32:35], s44 offen offset:2048 nt
    v_and_b32_dpp v20, v43, v8 row_newbcast:14 row_mask:0xf bank_mask:0xf
    v_and_b32_dpp v21, v43, v9 row_newbcast:14 row_mask:0xf bank_mask:0xf
    v_and_b32_dpp v22, v43, v10 row_newbcast:14 row_mask:0xf bank_mask:0xf
    v_and_b32_dpp v23, v43, v11 row_newbcast:14 row_mask:0xf bank_mask:0xf
    s_waitcnt vmcnt(20)
    s_nop 0
    v_mfma_f32_16x16x32_bf16 v[12:15], v[20:23], v[192:195], v[12:15]
    buffer_load_dwordx4 v[192:195], v2, s[32:35], s44 offen offset:3072 nt
    v_and_b32_dpp v16, v43, v8 row_newbcast:3 row_mask:0xf bank_mask:0xf
    v_and_b32_dpp v17, v43, v9 row_newbcast:3 row_mask:0xf bank_mask:0xf
    v_and_b32_dpp v18, v43, v10 row_newbcast:3 row_mask:0xf bank_mask:0xf
    v_and_b32_dpp v19, v43, v11 row_newbcast:3 row_mask:0xf bank_mask:0xf
    s_waitcnt vmcnt(20)
    s_nop 0
    v_mfma_f32_16x16x32_bf16 v[12:15], v[16:19], v[196:199], v[12:15]
    s_add_u32 s44, s37, 28672
    buffer_load_dwordx4 v[196:199], v2, s[32:35], s44 offen nt
    v_and_b32_dpp v20, v43, v8 row_newbcast:7 row_mask:0xf bank_mask:0xf
    v_and_b32_dpp v21, v43, v9 row_newbcast:7 row_mask:0xf bank_mask:0xf
    v_and_b32_dpp v22, v43, v10 row_newbcast:7 row_mask:0xf bank_mask:0xf
    v_and_b32_dpp v23, v43, v11 row_newbcast:7 row_mask:0xf bank_mask:0xf
    s_waitcnt vmcnt(20)
    s_nop 0
    v_mfma_f32_16x16x32_bf16 v[12:15], v[20:23], v[200:203], v[12:15]
    buffer_load_dwordx4 v[200:203], v2, s[32:35], s44 offen offset:1024 nt
    v_and_b32_dpp v16, v43, v8 row_newbcast:11 row_mask:0xf bank_mask:0xf
    v_and_b32_dpp v17, v43, v9 row_newbcast:11 row_mask:0xf bank_mask:0xf
    v_and_b32_dpp v18, v43, v10 row_newbcast:11 row_mask:0xf bank_mask:0xf
    v_and_b32_dpp v19, v43, v11 row_newbcast:11 row_mask:0xf bank_mask:0xf
    s_waitcnt vmcnt(20)
    s_nop 0
    v_mfma_f32_16x16x32_bf16 v[12:15], v[16:19], v[204:207], v[12:15]
    buffer_load_dwordx4 v[204:207], v2, s[32:35], s44 offen offset:2048 nt
    v_and_b32_dpp v20, v43, v8 row_newbcast:15 row_mask:0xf bank_mask:0xf
    v_and_b32_dpp v21, v43, v9 row_newbcast:15 row_mask:0xf bank_mask:0xf
    v_and_b32_dpp v22, v43, v10 row_newbcast:15 row_mask:0xf bank_mask:0xf
    v_and_b32_dpp v23, v43, v11 row_newbcast:15 row_mask:0xf bank_mask:0xf
    s_waitcnt vmcnt(20)
    s_nop 0
    v_mfma_f32_16x16x32_bf16 v[12:15], v[20:23], v[208:211], v[12:15]
    buffer_load_dwordx4 v[208:211], v2, s[32:35], s44 offen offset:3072 nt
    s_branch L_vdone
L_vb3:
    v_and_b32_dpp v16, v42, v8 row_newbcast:0 row_mask:0xf bank_mask:0xf
    v_and_b32_dpp v17, v42, v9 row_newbcast:0 row_mask:0xf bank_mask:0xf
    v_and_b32_dpp v18, v42, v10 row_newbcast:0 row_mask:0xf bank_mask:0xf
    v_and_b32_dpp v19, v42, v11 row_newbcast:0 row_mask:0xf bank_mask:0xf
    s_waitcnt vmcnt(21)
    s_nop 0
    v_mfma_f32_16x16x32_bf16 v[12:15], v[16:19], v[84:87], v[12:15]
    buffer_load_dwordx4 v[84:87], v2, s[32:35], s37 offen nt
    v_and_b32_dpp v20, v42, v8 row_newbcast:4 row_mask:0xf bank_mask:0xf
    v_and_b32_dpp v21, v42, v9 row_newbcast:4 row_mask:0xf bank_mask:0xf
    v_and_b32_dpp v22, v42, v10 row_newbcast:4 row_mask:0xf bank_mask:0xf
    v_and_b32_dpp v23, v42, v11 row_newbcast:4 row_mask:0xf bank_mask:0xf
    s_waitcnt vmcnt(21)
    s_nop 0
    v_mfma_f32_16x16x32_bf16 v[12:15], v[20:23], v[88:91], v[12:15]
    buffer_load_dwordx4 v[88:91], v2, s[32:35], s37 offen offset:1024 nt
    v_and_b32_dpp v16, v42, v8 row_newbcast:8 row_mask:0xf bank_mask:0xf
    v_and_b32_dpp v17, v42, v9 row_newbcast:8 row_mask:0xf bank_mask:0xf
    v_and_b32_dpp v18, v42, v10 row_newbcast:8 row_mask:0xf bank_mask:0xf
    v_and_b32_dpp v19, v42, v11 row_newbcast:8 row_mask:0xf bank_mask:0xf
    s_waitcnt vmcnt(21)
    s_nop 0
    v_mfma_f32_16x16x32_bf16 v[12:15], v[16:19], v[92:95], v[12:15]
    buffer_load_dwordx4 v[92:95], v2, s[32:35], s37 offen offset:2048 nt
    v_and_b32_dpp v20, v42, v8 row_newbcast:12 row_mask:0xf bank_mask:0xf
    v_and_b32_dpp v21, v42, v9 row_newbcast:12 row_mask:0xf bank_mask:0xf
    v_and_b32_dpp v22, v42, v10 row_newbcast:12 row_mask:0xf bank_mask:0xf
    v_and_b32_dpp v23, v42, v11 row_newbcast:12 row_mask:0xf bank_mask:0xf
    s_waitcnt vmcnt(21)
    s_nop 0
    v_mfma_f32_16x16x32_bf16 v[12:15], v[20:23], v[96:99], v[12:15]
    buffer_load_dwordx4 v[96:99], v2, s[32:35], s37 offen offset:3072 nt
    v_and_b32_dpp v16, v42, v8 row_newbcast:1 row_mask:0xf bank_mask:0xf
    v_and_b32_dpp v17, v42, v9 row_newbcast:1 row_mask:0xf bank_mask:0xf
    v_and_b32_dpp v18, v42, v10 row_newbcast:1 row_mask:0xf bank_mask:0xf
    v_and_b32_dpp v19, v42, v11 row_newbcast:1 row_mask:0xf bank_mask:0xf
    s_waitcnt vmcnt(21)
    s_nop 0
    v_mfma_f32_16x16x32_bf16 v[12:15], v[16:19], v[100:103], v[12:15]
    s_add_u32 s44, s37, 4096
    buffer_load_dwordx4 v[100:103], v2, s[32:35], s44 offen nt
    v_and_b32_dpp v20, v42, v8 row_newbcast:5 row_mask:0xf bank_mask:0xf
    v_and_b32_dpp v21, v42, v9 row_newbcast:5 row_mask:0xf bank_mask:0xf
    v_and_b32_dpp v22, v42, v10 row_newbcast:5 row_mask:0xf bank_mask:0xf
    v_and_b32_dpp v23, v42, v11 row_newbcast:5 row_mask:0xf bank_mask:0xf
    s_waitcnt vmcnt(21)
    s_nop 0
    v_mfma_f32_16x16x32_bf16 v[12:15], v[20:23], v[104:107], v[12:15]
    buffer_load_dwordx4 v[104:107], v2, s[32:35], s44 offen offset:1024 nt
    v_and_b32_dpp v16, v42, v8 row_newbcast:9 row_mask:0xf bank_mask:0xf
    v_and_b32_dpp v17, v42, v9 row_newbcast:9 row_mask:0xf bank_mask:0xf
    v_and_b32_dpp v18, v42, v10 row_newbcast:9 row_mask:0xf bank_mask:0xf
    v_and_b32_dpp v19, v42, v11 row_newbcast:9 row_mask:0xf bank_mask:0xf
    s_waitcnt vmcnt(21)
    s_nop 0
    v_mfma_f32_16x16x32_bf16 v[12:15], v[16:19], v[108:111], v[12:15]
    buffer_load_dwordx4 v[108:111], v2, s[32:35], s44 offen offset:2048 nt
    v_and_b32_dpp v20, v42, v8 row_newbcast:13 row_mask:0xf bank_mask:0xf
    v_and_b32_dpp v21, v42, v9 row_newbcast:13 row_mask:0xf bank_mask:0xf
    v_and_b32_dpp v22, v42, v10 row_newbcast:13 row_mask:0xf bank_mask:0xf
    v_and_b32_dpp v23, v42, v11 row_newbcast:13 row_mask:0xf bank_mask:0xf
    s_waitcnt vmcnt(21)
    s_nop 0
    v_mfma_f32_16x16x32_bf16 v[12:15], v[20:23], v[112:115], v[12:15]
    buffer_load_dwordx4 v[112:115], v2, s[32:35], s44 offen offset:3072 nt
    v_and_b32_dpp v16, v42, v8 row_newbcast:2 row_mask:0xf bank_mask:0xf
    v_and_b32_dpp v17, v42, v9 row_newbcast:2 row_mask:0xf bank_mask:0xf
    v_and_b32_dpp v18, v42, v10 row_newbcast:2 row_mask:0xf bank_mask:0xf
    v_and_b32_dpp v19, v42, v11 row_newbcast:2 row_mask:0xf bank_mask:0xf
    s_waitcnt vmcnt(21)
    s_nop 0
    v_mfma_f32_16x16x32_bf16 v[12:15], v[16:19], v[116:119], v[12:15]
    s_add_u32 s44, s37, 8192
    buffer_load_dwordx4 v[116:119], v2, s[32:35], s44 offen nt
    v_and_b32_dpp v20, v42, v8 row_newbcast:6 row_mask:0xf bank_mask:0xf
    v_and_b32_dpp v21, v42, v9 row_newbcast:6 row_mask:0xf bank_mask:0xf
    v_and_b32_dpp v22, v42, v10 row_newbcast:6 row_mask:0xf bank_mask:0xf
    v_and_b32_dpp v23, v42, v11 row_newbcast:6 row_mask:0xf bank_mask:0xf
    s_waitcnt vmcnt(21)
    s_nop 0
    v_mfma_f32_16x16x32_bf16 v[12:15], v[20:23], v[120:123], v[12:15]
    buffer_load_dwordx4 v[120:123], v2, s[32:35], s44 offen offset:1024 nt
    v_and_b32_dpp v16, v42, v8 row_newbcast:10 row_mask:0xf bank_mask:0xf
    v_and_b32_dpp v17, v42, v9 row_newbcast:10 row_mask:0xf bank_mask:0xf
    v_and_b32_dpp v18, v42, v10 row_newbcast:10 row_mask:0xf bank_mask:0xf
    v_and_b32_dpp v19, v42, v11 row_newbcast:10 row_mask:0xf bank_mask:0xf
    s_waitcnt vmcnt(21)
    s_nop 0
    v_mfma_f32_16x16x32_bf16 v[12:15], v[16:19], v[124:127], v[12:15]
    buffer_load_dwordx4 v[124:127], v2, s[32:35], s44 offen offset:2048 nt
    v_and_b32_dpp v20, v42, v8 row_newbcast:14 row_mask:0xf bank_mask:0xf
    v_and_b32_dpp v21, v42, v9 row_newbcast:14 row_mask:0xf bank_mask:0xf
    v_and_b32_dpp v22, v42, v10 row_newbcast:14 row_mask:0xf bank_mask:0xf
    v_and_b32_dpp v23, v42, v11 row_newbcast:14 row_mask:0xf bank_mask:0xf
    s_waitcnt vmcnt(21)
    s_nop 0
    v_mfma_f32_16x16x32_bf16 v[12:15], v[20:23], v[128:131], v[12:15]
    buffer_load_dwordx4 v[128:131], v2, s[32:35], s44 offen offset:3072 nt
    v_and_b32_dpp v16, v42, v8 row_newbcast:3 row_mask:0xf bank_mask:0xf
    v_and_b32_dpp v17, v42, v9 row_newbcast:3 row_mask:0xf bank_mask:0xf
    v_and_b32_dpp v18, v42, v10 row_newbcast:3 row_mask:0xf bank_mask:0xf
    v_and_b32_dpp v19, v42, v11 row_newbcast:3 row_mask:0xf bank_mask:0xf
    s_waitcnt vmcnt(21)
    s_nop 0
    v_mfma_f32_16x16x32_bf16 v[12:15], v[16:19], v[132:135], v[12:15]
    s_add_u32 s44, s37, 12288
    buffer_load_dwordx4 v[132:135], v2, s[32:35], s44 offen nt
    v_and_b32_dpp v20, v42, v8 row_newbcast:7 row_mask:0xf bank_mask:0xf
    v_and_b32_dpp v21, v42, v9 row_newbcast:7 row_mask:0xf bank_mask:0xf
    v_and_b32_dpp v22, v42, v10 row_newbcast:7 row_mask:0xf bank_mask:0xf
    v_and_b32_dpp v23, v42, v11 row_newbcast:7 row_mask:0xf bank_mask:0xf
    s_waitcnt vmcnt(21)
    s_nop 0
    v_mfma_f32_16x16x32_bf16 v[12:15], v[20:23], v[136:139], v[12:15]
    buffer_load_dwordx4 v[136:139], v2, s[32:35], s44 offen offset:1024 nt
    v_and_b32_dpp v16, v42, v8 row_newbcast:11 row_mask:0xf bank_mask:0xf
    v_and_b32_dpp v17, v42, v9 row_newbcast:11 row_mask:0xf bank_mask:0xf
    v_and_b32_dpp v18, v42, v10 row_newbcast:11 row_mask:0xf bank_mask:0xf
    v_and_b32_dpp v19, v42, v11 row_newbcast:11 row_mask:0xf bank_mask:0xf
    s_waitcnt vmcnt(21)
    s_nop 0
    v_mfma_f32_16x16x32_bf16 v[12:15], v[16:19], v[140:143], v[12:15]
    buffer_load_dwordx4 v[140:143], v2, s[32:35], s44 offen offset:2048 nt
    v_and_b32_dpp v20, v42, v8 row_newbcast:15 row_mask:0xf bank_mask:0xf
    v_and_b32_dpp v21, v42, v9 row_newbcast:15 row_mask:0xf bank_mask:0xf
    v_and_b32_dpp v22, v42, v10 row_newbcast:15 row_mask:0xf bank_mask:0xf
    v_and_b32_dpp v23, v42, v11 row_newbcast:15 row_mask:0xf bank_mask:0xf
    s_waitcnt vmcnt(21)
    s_nop 0
    v_mfma_f32_16x16x32_bf16 v[12:15], v[20:23], v[144:147], v[12:15]
    buffer_load_dwordx4 v[144:147], v2, s[32:35], s44 offen offset:3072 nt
    v_and_b32_dpp v16, v43, v8 row_newbcast:0 row_mask:0xf bank_mask:0xf
    v_and_b32_dpp v17, v43, v9 row_newbcast:0 row_mask:0xf bank_mask:0xf
    v_and_b32_dpp v18, v43, v10 row_newbcast:0 row_mask:0xf bank_mask:0xf
    v_and_b32_dpp v19, v43, v11 row_newbcast:0 row_mask:0xf bank_mask:0xf
    s_waitcnt vmcnt(21)
    s_nop 0
    v_mfma_f32_16x16x32_bf16 v[12:15], v[16:19], v[148:151], v[12:15]
    s_add_u32 s44, s37, 16384
    buffer_load_dwordx4 v[148:151], v2, s[32:35], s44 offen nt
    v_and_b32_dpp v20, v43, v8 row_newbcast:4 row_mask:0xf bank_mask:0xf
    v_and_b32_dpp v21, v43, v9 row_newbcast:4 row_mask:0xf bank_mask:0xf
    v_and_b32_dpp v22, v43, v10 row_newbcast:4 row_mask:0xf bank_mask:0xf
    v_and_b32_dpp v23, v43, v11 row_newbcast:4 row_mask:0xf bank_mask:0xf
    s_waitcnt vmcnt(21)
    s_nop 0
    v_mfma_f32_16x16x32_bf16 v[12:15], v[20:23], v[152:155], v[12:15]
    buffer_load_dwordx4 v[152:155], v2, s[32:35], s44 offen offset:1024 nt
    v_and_b32_dpp v16, v43, v8 row_newbcast:8 row_mask:0xf bank_mask:0xf
    v_and_b32_dpp v17, v43, v9 row_newbcast:8 row_mask:0xf bank_mask:0xf
    v_and_b32_dpp v18, v43, v10 row_newbcast:8 row_mask:0xf bank_mask:0xf
    v_and_b32_dpp v19, v43, v11 row_newbcast:8 row_mask:0xf bank_mask:0xf
    s_waitcnt vmcnt(21)
    s_nop 0
    v_mfma_f32_16x16x32_bf16 v[12:15], v[16:19], v[156:159], v[12:15]
    buffer_load_dwordx4 v[156:159], v2, s[32:35], s44 offen offset:2048 nt
    v_and_b32_dpp v20, v43, v8 row_newbcast:12 row_mask:0xf bank_mask:0xf
    v_and_b32_dpp v21, v43, v9 row_newbcast:12 row_mask:0xf bank_mask:0xf
    v_and_b32_dpp v22, v43, v10 row_newbcast:12 row_mask:0xf bank_mask:0xf
    v_and_b32_dpp v23, v43, v11 row_newbcast:12 row_mask:0xf bank_mask:0xf
    s_waitcnt vmcnt(21)
    s_nop 0
    v_mfma_f32_16x16x32_bf16 v[12:15], v[20:23], v[160:163], v[12:15]
    buffer_load_dwordx4 v[160:163], v2, s[32:35], s44 offen offset:3072 nt
    v_and_b32_dpp v16, v43, v8 row_newbcast:1 row_mask:0xf bank_mask:0xf
    v_and_b32_dpp v17, v43, v9 row_newbcast:1 row_mask:0xf bank_mask:0xf
    v_and_b32_dpp v18, v43, v10 row_newbcast:1 row_mask:0xf bank_mask:0xf
    v_and_b32_dpp v19, v43, v11 row_newbcast:1 row_mask:0xf bank_mask:0xf
    s_waitcnt vmcnt(21)
    s_nop 0
    v_mfma_f32_16x16x32_bf16 v[12:15], v[16:19], v[164:167], v[12:15]
    s_add_u32 s44, s37, 20480
    buffer_load_dwordx4 v[164:167], v2, s[32:35], s44 offen nt
    v_and_b32_dpp v20, v43, v8 row_newbcast:5 row_mask:0xf bank_mask:0xf
    v_and_b32_dpp v21, v43, v9 row_newbcast:5 row_mask:0xf bank_mask:0xf
    v_and_b32_dpp v22, v43, v10 row_newbcast:5 row_mask:0xf bank_mask:0xf
    v_and_b32_dpp v23, v43, v11 row_newbcast:5 row_mask:0xf bank_mask:0xf
    s_waitcnt vmcnt(21)
    s_nop 0
    v_mfma_f32_16x16x32_bf16 v[12:15], v[20:23], v[168:171], v[12:15]
    buffer_load_dwordx4 v[168:171], v2, s[32:35], s44 offen offset:1024 nt
    v_and_b32_dpp v16, v43, v8 row_newbcast:9 row_mask:0xf bank_mask:0xf
    v_and_b32_dpp v17, v43, v9 row_newbcast:9 row_mask:0xf bank_mask:0xf
    v_and_b32_dpp v18, v43, v10 row_newbcast:9 row_mask:0xf bank_mask:0xf
    v_and_b32_dpp v19, v43, v11 row_newbcast:9 row_mask:0xf bank_mask:0xf
    s_waitcnt vmcnt(21)
    s_nop 0
    v_mfma_f32_16x16x32_bf16 v[12:15], v[16:19], v[172:175], v[12:15]
    buffer_load_dwordx4 v[172:175], v2, s[32:35], s44 offen offset:2048 nt
    v_and_b32_dpp v20, v43, v8 row_newbcast:13 row_mask:0xf bank_mask:0xf
    v_and_b32_dpp v21, v43, v9 row_newbcast:13 row_mask:0xf bank_mask:0xf
    v_and_b32_dpp v22, v43, v10 row_newbcast:13 row_mask:0xf bank_mask:0xf
    v_and_b32_dpp v23, v43, v11 row_newbcast:13 row_mask:0xf bank_mask:0xf
    s_waitcnt vmcnt(21)
    s_nop 0
    v_mfma_f32_16x16x32_bf16 v[12:15], v[20:23], v[176:179], v[12:15]
    buffer_load_dwordx4 v[176:179], v2, s[32:35], s44 offen offset:3072 nt
    v_and_b32_dpp v16, v43, v8 row_newbcast:2 row_mask:0xf bank_mask:0xf
    v_and_b32_dpp v17, v43, v9 row_newbcast:2 row_mask:0xf bank_mask:0xf
    v_and_b32_dpp v18, v43, v10 row_newbcast:2 row_mask:0xf bank_mask:0xf
    v_and_b32_dpp v19, v43, v11 row_newbcast:2 row_mask:0xf bank_mask:0xf
    s_waitcnt vmcnt(21)
    s_nop 0
    v_mfma_f32_16x16x32_bf16 v[12:15], v[16:19], v[180:183], v[12:15]
    s_add_u32 s44, s37, 24576
    buffer_load_dwordx4 v[180:183], v2, s[32:35], s44 offen nt
    v_and_b32_dpp v20, v43, v8 row_newbcast:6 row_mask:0xf bank_mask:0xf
    v_and_b32_dpp v21, v43, v9 row_newbcast:6 row_mask:0xf bank_mask:0xf
    v_and_b32_dpp v22, v43, v10 row_newbcast:6 row_mask:0xf bank_mask:0xf
    v_and_b32_dpp v23, v43, v11 row_newbcast:6 row_mask:0xf bank_mask:0xf
    s_waitcnt vmcnt(21)
    s_nop 0
    v_mfma_f32_16x16x32_bf16 v[12:15], v[20:23], v[184:187], v[12:15]
    buffer_load_dwordx4 v[184:187], v2, s[32:35], s44 offen offset:1024 nt
    v_and_b32_dpp v16, v43, v8 row_newbcast:10 row_mask:0xf bank_mask:0xf
    v_and_b32_dpp v17, v43, v9 row_newbcast:10 row_mask:0xf bank_mask:0xf
    v_and_b32_dpp v18, v43, v10 row_newbcast:10 row_mask:0xf bank_mask:0xf
    v_and_b32_dpp v19, v43, v11 row_newbcast:10 row_mask:0xf bank_mask:0xf
    s_waitcnt vmcnt(21)
    s_nop 0
    v_mfma_f32_16x16x32_bf16 v[12:15], v[16:19], v[188:191], v[12:15]
    buffer_load_dwordx4 v[188:191], v2, s[32:35], s44 offen offset:2048 nt
    v_and_b32_dpp v20, v43, v8 row_newbcast:14 row_mask:0xf bank_mask:0xf
    v_and_b32_dpp v21, v43, v9 row_newbcast:14 row_mask:0xf bank_mask:0xf
    v_and_b32_dpp v22, v43, v10 row_newbcast:14 row_mask:0xf bank_mask:0xf
    v_and_b32_dpp v23, v43, v11 row_newbcast:14 row_mask:0xf bank_mask:0xf
    s_waitcnt vmcnt(21)
    s_nop 0
    v_mfma_f32_16x16x32_bf16 v[12:15], v[20:23], v[192:195], v[12:15]
    buffer_load_dwordx4 v[192:195], v2, s[32:35], s44 offen offset:3072 nt
    v_and_b32_dpp v16, v43, v8 row_newbcast:3 row_mask:0xf bank_mask:0xf
    v_and_b32_dpp v17, v43, v9 row_newbcast:3 row_mask:0xf bank_mask:0xf
    v_and_b32_dpp v18, v43, v10 row_newbcast:3 row_mask:0xf bank_mask:0xf
    v_and_b32_dpp v19, v43, v11 row_newbcast:3 row_mask:0xf bank_mask:0xf
    s_waitcnt vmcnt(21)
    s_nop 0
    v_mfma_f32_16x16x32_bf16 v[12:15], v[16:19], v[196:199], v[12:15]
    s_add_u32 s44, s37, 28672
    buffer_load_dwordx4 v[196:199], v2, s[32:35], s44 offen nt
    v_and_b32_dpp v20, v43, v8 row_newbcast:7 row_mask:0xf bank_mask:0xf
    v_and_b32_dpp v21, v43, v9 row_newbcast:7 row_mask:0xf bank_mask:0xf
    v_and_b32_dpp v22, v43, v10 row_newbcast:7 row_mask:0xf bank_mask:0xf
    v_and_b32_dpp v23, v43, v11 row_newbcast:7 row_mask:0xf bank_mask:0xf
    s_waitcnt vmcnt(21)
    s_nop 0
    v_mfma_f32_16x16x32_bf16 v[12:15], v[20:23], v[200:203], v[12:15]
    buffer_load_dwordx4 v[200:203], v2, s[32:35], s44 offen offset:1024 nt
    v_and_b32_dpp v16, v43, v8 row_newbcast:11 row_mask:0xf bank_mask:0xf
    v_and_b32_dpp v17, v43, v9 row_newbcast:11 row_mask:0xf bank_mask:0xf
    v_and_b32_dpp v18, v43, v10 row_newbcast:11 row_mask:0xf bank_mask:0xf
    v_and_b32_dpp v19, v43, v11 row_newbcast:11 row_mask:0xf bank_mask:0xf
    s_waitcnt vmcnt(21)
    s_nop 0
    v_mfma_f32_16x16x32_bf16 v[12:15], v[16:19], v[204:207], v[12:15]
    buffer_load_dwordx4 v[204:207], v2, s[32:35], s44 offen offset:2048 nt
    v_and_b32_dpp v20, v43, v8 row_newbcast:15 row_mask:0xf bank_mask:0xf
    v_and_b32_dpp v21, v43, v9 row_newbcast:15 row_mask:0xf bank_mask:0xf
    v_and_b32_dpp v22, v43, v10 row_newbcast:15 row_mask:0xf bank_mask:0xf
    v_and_b32_dpp v23, v43, v11 row_newbcast:15 row_mask:0xf bank_mask:0xf
    s_waitcnt vmcnt(21)
    s_nop 0
    v_mfma_f32_16x16x32_bf16 v[12:15], v[20:23], v[208:211], v[12:15]
    buffer_load_dwordx4 v[208:211], v2, s[32:35], s44 offen offset:3072 nt
    s_branch L_vdone
L_vb4:
    v_and_b32_dpp v16, v42, v8 row_newbcast:0 row_mask:0xf bank_mask:0xf
    v_and_b32_dpp v17, v42, v9 row_newbcast:0 row_mask:0xf bank_mask:0xf
    v_and_b32_dpp v18, v42, v10 row_newbcast:0 row_mask:0xf bank_mask:0xf
    v_and_b32_dpp v19, v42, v11 row_newbcast:0 row_mask:0xf bank_mask:0xf
    s_waitcnt vmcnt(23)
    s_nop 0
    v_mfma_f32_16x16x32_bf16 v[12:15], v[16:19], v[84:87], v[12:15]
    buffer_load_dwordx4 v[84:87], v2, s[32:35], s37 offen nt
    v_and_b32_dpp v20, v42, v8 row_newbcast:4 row_mask:0xf bank_mask:0xf
    v_and_b32_dpp v21, v42, v9 row_newbcast:4 row_mask:0xf bank_mask:0xf
    v_and_b32_dpp v22, v42, v10 row_newbcast:4 row_mask:0xf bank_mask:0xf
    v_and_b32_dpp v23, v42, v11 row_newbcast:4 row_mask:0xf bank_mask:0xf
    s_waitcnt vmcnt(23)
    s_nop 0
    v_mfma_f32_16x16x32_bf16 v[12:15], v[20:23], v[88:91], v[12:15]
    buffer_load_dwordx4 v[88:91], v2, s[32:35], s37 offen offset:1024 nt
    v_and_b32_dpp v16, v42, v8 row_newbcast:8 row_mask:0xf bank_mask:0xf
    v_and_b32_dpp v17, v42, v9 row_newbcast:8 row_mask:0xf bank_mask:0xf
    v_and_b32_dpp v18, v42, v10 row_newbcast:8 row_mask:0xf bank_mask:0xf
    v_and_b32_dpp v19, v42, v11 row_newbcast:8 row_mask:0xf bank_mask:0xf
    s_waitcnt vmcnt(23)
    s_nop 0
    v_mfma_f32_16x16x32_bf16 v[12:15], v[16:19], v[92:95], v[12:15]
    buffer_load_dwordx4 v[92:95], v2, s[32:35], s37 offen offset:2048 nt
    v_and_b32_dpp v20, v42, v8 row_newbcast:12 row_mask:0xf bank_mask:0xf
    v_and_b32_dpp v21, v42, v9 row_newbcast:12 row_mask:0xf bank_mask:0xf
    v_and_b32_dpp v22, v42, v10 row_newbcast:12 row_mask:0xf bank_mask:0xf
    v_and_b32_dpp v23, v42, v11 row_newbcast:12 row_mask:0xf bank_mask:0xf
    s_waitcnt vmcnt(23)
    s_nop 0
    v_mfma_f32_16x16x32_bf16 v[12:15], v[20:23], v[96:99], v[12:15]
    buffer_load_dwordx4 v[96:99], v2, s[32:35], s37 offen offset:3072 nt
    v_and_b32_dpp v16, v42, v8 row_newbcast:1 row_mask:0xf bank_mask:0xf
    v_and_b32_dpp v17, v42, v9 row_newbcast:1 row_mask:0xf bank_mask:0xf
    v_and_b32_dpp v18, v42, v10 row_newbcast:1 row_mask:0xf bank_mask:0xf
    v_and_b32_dpp v19, v42, v11 row_newbcast:1 row_mask:0xf bank_mask:0xf
    s_waitcnt vmcnt(23)
    s_nop 0
    v_mfma_f32_16x16x32_bf16 v[12:15], v[16:19], v[100:103], v[12:15]
    s_add_u32 s44, s37, 4096
    buffer_load_dwordx4 v[100:103], v2, s[32:35], s44 offen nt
    v_and_b32_dpp v20, v42, v8 row_newbcast:5 row_mask:0xf bank_mask:0xf
    v_and_b32_dpp v21, v42, v9 row_newbcast:5 row_mask:0xf bank_mask:0xf
    v_and_b32_dpp v22, v42, v10 row_newbcast:5 row_mask:0xf bank_mask:0xf
    v_and_b32_dpp v23, v42, v11 row_newbcast:5 row_mask:0xf bank_mask:0xf
    s_waitcnt vmcnt(23)
    s_nop 0
    v_mfma_f32_16x16x32_bf16 v[12:15], v[20:23], v[104:107], v[12:15]
    buffer_load_dwordx4 v[104:107], v2, s[32:35], s44 offen offset:1024 nt
    v_and_b32_dpp v16, v42, v8 row_newbcast:9 row_mask:0xf bank_mask:0xf
    v_and_b32_dpp v17, v42, v9 row_newbcast:9 row_mask:0xf bank_mask:0xf
    v_and_b32_dpp v18, v42, v10 row_newbcast:9 row_mask:0xf bank_mask:0xf
    v_and_b32_dpp v19, v42, v11 row_newbcast:9 row_mask:0xf bank_mask:0xf
    s_waitcnt vmcnt(23)
    s_nop 0
    v_mfma_f32_16x16x32_bf16 v[12:15], v[16:19], v[108:111], v[12:15]
    buffer_load_dwordx4 v[108:111], v2, s[32:35], s44 offen offset:2048 nt
    v_and_b32_dpp v20, v42, v8 row_newbcast:13 row_mask:0xf bank_mask:0xf
    v_and_b32_dpp v21, v42, v9 row_newbcast:13 row_mask:0xf bank_mask:0xf
    v_and_b32_dpp v22, v42, v10 row_newbcast:13 row_mask:0xf bank_mask:0xf
    v_and_b32_dpp v23, v42, v11 row_newbcast:13 row_mask:0xf bank_mask:0xf
    s_waitcnt vmcnt(23)
    s_nop 0
    v_mfma_f32_16x16x32_bf16 v[12:15], v[20:23], v[112:115], v[12:15]
    buffer_load_dwordx4 v[112:115], v2, s[32:35], s44 offen offset:3072 nt
    v_and_b32_dpp v16, v42, v8 row_newbcast:2 row_mask:0xf bank_mask:0xf
    v_and_b32_dpp v17, v42, v9 row_newbcast:2 row_mask:0xf bank_mask:0xf
    v_and_b32_dpp v18, v42, v10 row_newbcast:2 row_mask:0xf bank_mask:0xf
    v_and_b32_dpp v19, v42, v11 row_newbcast:2 row_mask:0xf bank_mask:0xf
    s_waitcnt vmcnt(23)
    s_nop 0
    v_mfma_f32_16x16x32_bf16 v[12:15], v[16:19], v[116:119], v[12:15]
    s_add_u32 s44, s37, 8192
    buffer_load_dwordx4 v[116:119], v2, s[32:35], s44 offen nt
    v_and_b32_dpp v20, v42, v8 row_newbcast:6 row_mask:0xf bank_mask:0xf
    v_and_b32_dpp v21, v42, v9 row_newbcast:6 row_mask:0xf bank_mask:0xf
    v_and_b32_dpp v22, v42, v10 row_newbcast:6 row_mask:0xf bank_mask:0xf
    v_and_b32_dpp v23, v42, v11 row_newbcast:6 row_mask:0xf bank_mask:0xf
    s_waitcnt vmcnt(23)
    s_nop 0
    v_mfma_f32_16x16x32_bf16 v[12:15], v[20:23], v[120:123], v[12:15]
    buffer_load_dwordx4 v[120:123], v2, s[32:35], s44 offen offset:1024 nt
    v_and_b32_dpp v16, v42, v8 row_newbcast:10 row_mask:0xf bank_mask:0xf
    v_and_b32_dpp v17, v42, v9 row_newbcast:10 row_mask:0xf bank_mask:0xf
    v_and_b32_dpp v18, v42, v10 row_newbcast:10 row_mask:0xf bank_mask:0xf
    v_and_b32_dpp v19, v42, v11 row_newbcast:10 row_mask:0xf bank_mask:0xf
    s_waitcnt vmcnt(23)
    s_nop 0
    v_mfma_f32_16x16x32_bf16 v[12:15], v[16:19], v[124:127], v[12:15]
    buffer_load_dwordx4 v[124:127], v2, s[32:35], s44 offen offset:2048 nt
    v_and_b32_dpp v20, v42, v8 row_newbcast:14 row_mask:0xf bank_mask:0xf
    v_and_b32_dpp v21, v42, v9 row_newbcast:14 row_mask:0xf bank_mask:0xf
    v_and_b32_dpp v22, v42, v10 row_newbcast:14 row_mask:0xf bank_mask:0xf
    v_and_b32_dpp v23, v42, v11 row_newbcast:14 row_mask:0xf bank_mask:0xf
    s_waitcnt vmcnt(23)
    s_nop 0
    v_mfma_f32_16x16x32_bf16 v[12:15], v[20:23], v[128:131], v[12:15]
    buffer_load_dwordx4 v[128:131], v2, s[32:35], s44 offen offset:3072 nt
    v_and_b32_dpp v16, v42, v8 row_newbcast:3 row_mask:0xf bank_mask:0xf
    v_and_b32_dpp v17, v42, v9 row_newbcast:3 row_mask:0xf bank_mask:0xf
    v_and_b32_dpp v18, v42, v10 row_newbcast:3 row_mask:0xf bank_mask:0xf
    v_and_b32_dpp v19, v42, v11 row_newbcast:3 row_mask:0xf bank_mask:0xf
    s_waitcnt vmcnt(23)
    s_nop 0
    v_mfma_f32_16x16x32_bf16 v[12:15], v[16:19], v[132:135], v[12:15]
    s_add_u32 s44, s37, 12288
    buffer_load_dwordx4 v[132:135], v2, s[32:35], s44 offen nt
    v_and_b32_dpp v20, v42, v8 row_newbcast:7 row_mask:0xf bank_mask:0xf
    v_and_b32_dpp v21, v42, v9 row_newbcast:7 row_mask:0xf bank_mask:0xf
    v_and_b32_dpp v22, v42, v10 row_newbcast:7 row_mask:0xf bank_mask:0xf
    v_and_b32_dpp v23, v42, v11 row_newbcast:7 row_mask:0xf bank_mask:0xf
    s_waitcnt vmcnt(23)
    s_nop 0
    v_mfma_f32_16x16x32_bf16 v[12:15], v[20:23], v[136:139], v[12:15]
    buffer_load_dwordx4 v[136:139], v2, s[32:35], s44 offen offset:1024 nt
    v_and_b32_dpp v16, v42, v8 row_newbcast:11 row_mask:0xf bank_mask:0xf
    v_and_b32_dpp v17, v42, v9 row_newbcast:11 row_mask:0xf bank_mask:0xf
    v_and_b32_dpp v18, v42, v10 row_newbcast:11 row_mask:0xf bank_mask:0xf
    v_and_b32_dpp v19, v42, v11 row_newbcast:11 row_mask:0xf bank_mask:0xf
    s_waitcnt vmcnt(23)
    s_nop 0
    v_mfma_f32_16x16x32_bf16 v[12:15], v[16:19], v[140:143], v[12:15]
    buffer_load_dwordx4 v[140:143], v2, s[32:35], s44 offen offset:2048 nt
    v_and_b32_dpp v20, v42, v8 row_newbcast:15 row_mask:0xf bank_mask:0xf
    v_and_b32_dpp v21, v42, v9 row_newbcast:15 row_mask:0xf bank_mask:0xf
    v_and_b32_dpp v22, v42, v10 row_newbcast:15 row_mask:0xf bank_mask:0xf
    v_and_b32_dpp v23, v42, v11 row_newbcast:15 row_mask:0xf bank_mask:0xf
    s_waitcnt vmcnt(23)
    s_nop 0
    v_mfma_f32_16x16x32_bf16 v[12:15], v[20:23], v[144:147], v[12:15]
    buffer_load_dwordx4 v[144:147], v2, s[32:35], s44 offen offset:3072 nt
    v_and_b32_dpp v16, v43, v8 row_newbcast:0 row_mask:0xf bank_mask:0xf
    v_and_b32_dpp v17, v43, v9 row_newbcast:0 row_mask:0xf bank_mask:0xf
    v_and_b32_dpp v18, v43, v10 row_newbcast:0 row_mask:0xf bank_mask:0xf
    v_and_b32_dpp v19, v43, v11 row_newbcast:0 row_mask:0xf bank_mask:0xf
    s_waitcnt vmcnt(23)
    s_nop 0
    v_mfma_f32_16x16x32_bf16 v[12:15], v[16:19], v[148:151], v[12:15]
    s_add_u32 s44, s37, 16384
    buffer_load_dwordx4 v[148:151], v2, s[32:35], s44 offen nt
    v_and_b32_dpp v20, v43, v8 row_newbcast:4 row_mask:0xf bank_mask:0xf
    v_and_b32_dpp v21, v43, v9 row_newbcast:4 row_mask:0xf bank_mask:0xf
    v_and_b32_dpp v22, v43, v10 row_newbcast:4 row_mask:0xf bank_mask:0xf
    v_and_b32_dpp v23, v43, v11 row_newbcast:4 row_mask:0xf bank_mask:0xf
    s_waitcnt vmcnt(23)
    s_nop 0
    v_mfma_f32_16x16x32_bf16 v[12:15], v[20:23], v[152:155], v[12:15]
    buffer_load_dwordx4 v[152:155], v2, s[32:35], s44 offen offset:1024 nt
    v_and_b32_dpp v16, v43, v8 row_newbcast:8 row_mask:0xf bank_mask:0xf
    v_and_b32_dpp v17, v43, v9 row_newbcast:8 row_mask:0xf bank_mask:0xf
    v_and_b32_dpp v18, v43, v10 row_newbcast:8 row_mask:0xf bank_mask:0xf
    v_and_b32_dpp v19, v43, v11 row_newbcast:8 row_mask:0xf bank_mask:0xf
    s_waitcnt vmcnt(23)
    s_nop 0
    v_mfma_f32_16x16x32_bf16 v[12:15], v[16:19], v[156:159], v[12:15]
    buffer_load_dwordx4 v[156:159], v2, s[32:35], s44 offen offset:2048 nt
    v_and_b32_dpp v20, v43, v8 row_newbcast:12 row_mask:0xf bank_mask:0xf
    v_and_b32_dpp v21, v43, v9 row_newbcast:12 row_mask:0xf bank_mask:0xf
    v_and_b32_dpp v22, v43, v10 row_newbcast:12 row_mask:0xf bank_mask:0xf
    v_and_b32_dpp v23, v43, v11 row_newbcast:12 row_mask:0xf bank_mask:0xf
    s_waitcnt vmcnt(23)
    s_nop 0
    v_mfma_f32_16x16x32_bf16 v[12:15], v[20:23], v[160:163], v[12:15]
    buffer_load_dwordx4 v[160:163], v2, s[32:35], s44 offen offset:3072 nt
    v_and_b32_dpp v16, v43, v8 row_newbcast:1 row_mask:0xf bank_mask:0xf
    v_and_b32_dpp v17, v43, v9 row_newbcast:1 row_mask:0xf bank_mask:0xf
    v_and_b32_dpp v18, v43, v10 row_newbcast:1 row_mask:0xf bank_mask:0xf
    v_and_b32_dpp v19, v43, v11 row_newbcast:1 row_mask:0xf bank_mask:0xf
    s_waitcnt vmcnt(23)
    s_nop 0
    v_mfma_f32_16x16x32_bf16 v[12:15], v[16:19], v[164:167], v[12:15]
    s_add_u32 s44, s37, 20480
    buffer_load_dwordx4 v[164:167], v2, s[32:35], s44 offen nt
    v_and_b32_dpp v20, v43, v8 row_newbcast:5 row_mask:0xf bank_mask:0xf
    v_and_b32_dpp v21, v43, v9 row_newbcast:5 row_mask:0xf bank_mask:0xf
    v_and_b32_dpp v22, v43, v10 row_newbcast:5 row_mask:0xf bank_mask:0xf
    v_and_b32_dpp v23, v43, v11 row_newbcast:5 row_mask:0xf bank_mask:0xf
    s_waitcnt vmcnt(23)
    s_nop 0
    v_mfma_f32_16x16x32_bf16 v[12:15], v[20:23], v[168:171], v[12:15]
    buffer_load_dwordx4 v[168:171], v2, s[32:35], s44 offen offset:1024 nt
    v_and_b32_dpp v16, v43, v8 row_newbcast:9 row_mask:0xf bank_mask:0xf
    v_and_b32_dpp v17, v43, v9 row_newbcast:9 row_mask:0xf bank_mask:0xf
    v_and_b32_dpp v18, v43, v10 row_newbcast:9 row_mask:0xf bank_mask:0xf
    v_and_b32_dpp v19, v43, v11 row_newbcast:9 row_mask:0xf bank_mask:0xf
    s_waitcnt vmcnt(23)
    s_nop 0
    v_mfma_f32_16x16x32_bf16 v[12:15], v[16:19], v[172:175], v[12:15]
    buffer_load_dwordx4 v[172:175], v2, s[32:35], s44 offen offset:2048 nt
    v_and_b32_dpp v20, v43, v8 row_newbcast:13 row_mask:0xf bank_mask:0xf
    v_and_b32_dpp v21, v43, v9 row_newbcast:13 row_mask:0xf bank_mask:0xf
    v_and_b32_dpp v22, v43, v10 row_newbcast:13 row_mask:0xf bank_mask:0xf
    v_and_b32_dpp v23, v43, v11 row_newbcast:13 row_mask:0xf bank_mask:0xf
    s_waitcnt vmcnt(23)
    s_nop 0
    v_mfma_f32_16x16x32_bf16 v[12:15], v[20:23], v[176:179], v[12:15]
    buffer_load_dwordx4 v[176:179], v2, s[32:35], s44 offen offset:3072 nt
    v_and_b32_dpp v16, v43, v8 row_newbcast:2 row_mask:0xf bank_mask:0xf
    v_and_b32_dpp v17, v43, v9 row_newbcast:2 row_mask:0xf bank_mask:0xf
    v_and_b32_dpp v18, v43, v10 row_newbcast:2 row_mask:0xf bank_mask:0xf
    v_and_b32_dpp v19, v43, v11 row_newbcast:2 row_mask:0xf bank_mask:0xf
    s_waitcnt vmcnt(23)
    s_nop 0
    v_mfma_f32_16x16x32_bf16 v[12:15], v[16:19], v[180:183], v[12:15]
    s_add_u32 s44, s37, 24576
    buffer_load_dwordx4 v[180:183], v2, s[32:35], s44 offen nt
    v_and_b32_dpp v20, v43, v8 row_newbcast:6 row_mask:0xf bank_mask:0xf
    v_and_b32_dpp v21, v43, v9 row_newbcast:6 row_mask:0xf bank_mask:0xf
    v_and_b32_dpp v22, v43, v10 row_newbcast:6 row_mask:0xf bank_mask:0xf
    v_and_b32_dpp v23, v43, v11 row_newbcast:6 row_mask:0xf bank_mask:0xf
    s_waitcnt vmcnt(23)
    s_nop 0
    v_mfma_f32_16x16x32_bf16 v[12:15], v[20:23], v[184:187], v[12:15]
    buffer_load_dwordx4 v[184:187], v2, s[32:35], s44 offen offset:1024 nt
    v_and_b32_dpp v16, v43, v8 row_newbcast:10 row_mask:0xf bank_mask:0xf
    v_and_b32_dpp v17, v43, v9 row_newbcast:10 row_mask:0xf bank_mask:0xf
    v_and_b32_dpp v18, v43, v10 row_newbcast:10 row_mask:0xf bank_mask:0xf
    v_and_b32_dpp v19, v43, v11 row_newbcast:10 row_mask:0xf bank_mask:0xf
    s_waitcnt vmcnt(23)
    s_nop 0
    v_mfma_f32_16x16x32_bf16 v[12:15], v[16:19], v[188:191], v[12:15]
    buffer_load_dwordx4 v[188:191], v2, s[32:35], s44 offen offset:2048 nt
    v_and_b32_dpp v20, v43, v8 row_newbcast:14 row_mask:0xf bank_mask:0xf
    v_and_b32_dpp v21, v43, v9 row_newbcast:14 row_mask:0xf bank_mask:0xf
    v_and_b32_dpp v22, v43, v10 row_newbcast:14 row_mask:0xf bank_mask:0xf
    v_and_b32_dpp v23, v43, v11 row_newbcast:14 row_mask:0xf bank_mask:0xf
    s_waitcnt vmcnt(23)
    s_nop 0
    v_mfma_f32_16x16x32_bf16 v[12:15], v[20:23], v[192:195], v[12:15]
    buffer_load_dwordx4 v[192:195], v2, s[32:35], s44 offen offset:3072 nt
    v_and_b32_dpp v16, v43, v8 row_newbcast:3 row_mask:0xf bank_mask:0xf
    v_and_b32_dpp v17, v43, v9 row_newbcast:3 row_mask:0xf bank_mask:0xf
    v_and_b32_dpp v18, v43, v10 row_newbcast:3 row_mask:0xf bank_mask:0xf
    v_and_b32_dpp v19, v43, v11 row_newbcast:3 row_mask:0xf bank_mask:0xf
    s_waitcnt vmcnt(23)
    s_nop 0
    v_mfma_f32_16x16x32_bf16 v[12:15], v[16:19], v[196:199], v[12:15]
    s_add_u32 s44, s37, 28672
    buffer_load_dwordx4 v[196:199], v2, s[32:35], s44 offen nt
    v_and_b32_dpp v20, v43, v8 row_newbcast:7 row_mask:0xf bank_mask:0xf
    v_and_b32_dpp v21, v43, v9 row_newbcast:7 row_mask:0xf bank_mask:0xf
    v_and_b32_dpp v22, v43, v10 row_newbcast:7 row_mask:0xf bank_mask:0xf
    v_and_b32_dpp v23, v43, v11 row_newbcast:7 row_mask:0xf bank_mask:0xf
    s_waitcnt vmcnt(23)
    s_nop 0
    v_mfma_f32_16x16x32_bf16 v[12:15], v[20:23], v[200:203], v[12:15]
    buffer_load_dwordx4 v[200:203], v2, s[32:35], s44 offen offset:1024 nt
    v_and_b32_dpp v16, v43, v8 row_newbcast:11 row_mask:0xf bank_mask:0xf
    v_and_b32_dpp v17, v43, v9 row_newbcast:11 row_mask:0xf bank_mask:0xf
    v_and_b32_dpp v18, v43, v10 row_newbcast:11 row_mask:0xf bank_mask:0xf
    v_and_b32_dpp v19, v43, v11 row_newbcast:11 row_mask:0xf bank_mask:0xf
    s_waitcnt vmcnt(23)
    s_nop 0
    v_mfma_f32_16x16x32_bf16 v[12:15], v[16:19], v[204:207], v[12:15]
    buffer_load_dwordx4 v[204:207], v2, s[32:35], s44 offen offset:2048 nt
    v_and_b32_dpp v20, v43, v8 row_newbcast:15 row_mask:0xf bank_mask:0xf
    v_and_b32_dpp v21, v43, v9 row_newbcast:15 row_mask:0xf bank_mask:0xf
    v_and_b32_dpp v22, v43, v10 row_newbcast:15 row_mask:0xf bank_mask:0xf
    v_and_b32_dpp v23, v43, v11 row_newbcast:15 row_mask:0xf bank_mask:0xf
    s_waitcnt vmcnt(23)
    s_nop 0
    v_mfma_f32_16x16x32_bf16 v[12:15], v[20:23], v[208:211], v[12:15]
    buffer_load_dwordx4 v[208:211], v2, s[32:35], s44 offen offset:3072 nt
    s_branch L_vdone
L_vlast:
    s_and_b32 s42, s2, 3
    s_lshl_b32 s46, s41, 12
    s_add_u32 s44, s42, 1
    s_and_b32 s44, s44, 3
    s_lshl_b32 s44, s44, 10
    s_add_u32 s56, s46, s44
    s_add_u32 s44, s42, 2
    s_and_b32 s44, s44, 3
    s_lshl_b32 s44, s44, 10
    s_add_u32 s57, s46, s44
    s_add_u32 s44, s42, 3
    s_and_b32 s44, s44, 3
    s_lshl_b32 s44, s44, 10
    s_add_u32 s58, s46, s44
    v_add_f32_dpp v28, v28, v28 quad_perm:[1,0,3,2] row_mask:0xf bank_mask:0xf
    s_nop 1
    v_add_f32_dpp v28, v28, v28 quad_perm:[2,3,0,1] row_mask:0xf bank_mask:0xf
    s_nop 1
    v_add_f32_dpp v28, v28, v28 row_half_mirror row_mask:0xf bank_mask:0xf
    s_nop 1
    v_add_f32_dpp v28, v28, v28 row_mirror row_mask:0xf bank_mask:0xf
    s_nop 1
    v_add_f32_dpp v28, v28, v28 row_bcast:15 row_mask:0xa bank_mask:0xf
    s_nop 1
    v_add_f32_dpp v28, v28, v28 row_bcast:31 row_mask:0xc bank_mask:0xf
    s_nop 1
    v_readlane_b32 s48, v28, 63
    s_lshr_b64 s[86:87], s[86:87], 8
    s_lshl_b32 s36, s2, 10
    v_log_f32 v44, s48
    v_rcp_f32 v37, s48
    v_and_b32 v45, 0xf0, v2
    v_bfe_u32 v29, v0, 4, 1
    v_lshl_add_u32 v45, v29, 3, v45
    v_lshrrev_b32 v29, 5, v0
    v_lshl_add_u32 v45, v29, 2, v45
    v_add_f32 v44, v44, v36
    v_lshlrev_b32 v29, 26, v0
    v_add_u32 v1, s51, v29
    v_add_u32 v46, s86, v29
    s_mov_b32 s50, 0
    v_mov_b32 v34, v46
    v_mov_b32 v35, v44
    v_and_b32_dpp v16, v42, v8 row_newbcast:0 row_mask:0xf bank_mask:0xf
    v_and_b32_dpp v17, v42, v9 row_newbcast:0 row_mask:0xf bank_mask:0xf
    v_and_b32_dpp v18, v42, v10 row_newbcast:0 row_mask:0xf bank_mask:0xf
    v_and_b32_dpp v19, v42, v11 row_newbcast:0 row_mask:0xf bank_mask:0xf
    s_waitcnt vmcnt(31)
    s_nop 0
    v_mfma_f32_16x16x32_bf16 v[12:15], v[16:19], v[84:87], v[12:15]
    v_and_b32_dpp v20, v42, v8 row_newbcast:4 row_mask:0xf bank_mask:0xf
    v_and_b32_dpp v21, v42, v9 row_newbcast:4 row_mask:0xf bank_mask:0xf
    v_and_b32_dpp v22, v42, v10 row_newbcast:4 row_mask:0xf bank_mask:0xf
    v_and_b32_dpp v23, v42, v11 row_newbcast:4 row_mask:0xf bank_mask:0xf
    s_waitcnt vmcnt(30)
    s_nop 0
    v_mfma_f32_16x16x32_bf16 v[12:15], v[20:23], v[88:91], v[12:15]
    v_and_b32_dpp v16, v42, v8 row_newbcast:8 row_mask:0xf bank_mask:0xf
    v_and_b32_dpp v17, v42, v9 row_newbcast:8 row_mask:0xf bank_mask:0xf
    v_and_b32_dpp v18, v42, v10 row_newbcast:8 row_mask:0xf bank_mask:0xf
    v_and_b32_dpp v19, v42, v11 row_newbcast:8 row_mask:0xf bank_mask:0xf
    s_waitcnt vmcnt(29)
    s_nop 0
    v_mfma_f32_16x16x32_bf16 v[12:15], v[16:19], v[92:95], v[12:15]
    v_and_b32_dpp v20, v42, v8 row_newbcast:12 row_mask:0xf bank_mask:0xf
    v_and_b32_dpp v21, v42, v9 row_newbcast:12 row_mask:0xf bank_mask:0xf
    v_and_b32_dpp v22, v42, v10 row_newbcast:12 row_mask:0xf bank_mask:0xf
    v_and_b32_dpp v23, v42, v11 row_newbcast:12 row_mask:0xf bank_mask:0xf
    s_waitcnt vmcnt(28)
    s_nop 0
    v_mfma_f32_16x16x32_bf16 v[12:15], v[20:23], v[96:99], v[12:15]
    v_and_b32_dpp v16, v42, v8 row_newbcast:1 row_mask:0xf bank_mask:0xf
    v_and_b32_dpp v17, v42, v9 row_newbcast:1 row_mask:0xf bank_mask:0xf
    v_and_b32_dpp v18, v42, v10 row_newbcast:1 row_mask:0xf bank_mask:0xf
    v_and_b32_dpp v19, v42, v11 row_newbcast:1 row_mask:0xf bank_mask:0xf
    s_waitcnt vmcnt(27)
    s_nop 0
    v_mfma_f32_16x16x32_bf16 v[12:15], v[16:19], v[100:103], v[12:15]
    v_and_b32_dpp v20, v42, v8 row_newbcast:5 row_mask:0xf bank_mask:0xf
    v_and_b32_dpp v21, v42, v9 row_newbcast:5 row_mask:0xf bank_mask:0xf
    v_and_b32_dpp v22, v42, v10 row_newbcast:5 row_mask:0xf bank_mask:0xf
    v_and_b32_dpp v23, v42, v11 row_newbcast:5 row_mask:0xf bank_mask:0xf
    s_waitcnt vmcnt(26)
    s_nop 0
    v_mfma_f32_16x16x32_bf16 v[12:15], v[20:23], v[104:107], v[12:15]
    v_and_b32_dpp v16, v42, v8 row_newbcast:9 row_mask:0xf bank_mask:0xf
    v_and_b32_dpp v17, v42, v9 row_newbcast:9 row_mask:0xf bank_mask:0xf
    v_and_b32_dpp v18, v42, v10 row_newbcast:9 row_mask:0xf bank_mask:0xf
    v_and_b32_dpp v19, v42, v11 row_newbcast:9 row_mask:0xf bank_mask:0xf
    s_waitcnt vmcnt(25)
    s_nop 0
    v_mfma_f32_16x16x32_bf16 v[12:15], v[16:19], v[108:111], v[12:15]
    v_and_b32_dpp v20, v42, v8 row_newbcast:13 row_mask:0xf bank_mask:0xf
    v_and_b32_dpp v21, v42, v9 row_newbcast:13 row_mask:0xf bank_mask:0xf
    v_and_b32_dpp v22, v42, v10 row_newbcast:13 row_mask:0xf bank_mask:0xf
    v_and_b32_dpp v23, v42, v11 row_newbcast:13 row_mask:0xf bank_mask:0xf
    s_waitcnt vmcnt(24)
    s_nop 0
    v_mfma_f32_16x16x32_bf16 v[12:15], v[20:23], v[112:115], v[12:15]
    v_and_b32_dpp v16, v42, v8 row_newbcast:2 row_mask:0xf bank_mask:0xf
    v_and_b32_dpp v17, v42, v9 row_newbcast:2 row_mask:0xf bank_mask:0xf
    v_and_b32_dpp v18, v42, v10 row_newbcast:2 row_mask:0xf bank_mask:0xf
    v_and_b32_dpp v19, v42, v11 row_newbcast:2 row_mask:0xf bank_mask:0xf
    s_waitcnt vmcnt(23)
    s_nop 0
    v_mfma_f32_16x16x32_bf16 v[12:15], v[16:19], v[116:119], v[12:15]
    v_and_b32_dpp v20, v42, v8 row_newbcast:6 row_mask:0xf bank_mask:0xf
    v_and_b32_dpp v21, v42, v9 row_newbcast:6 row_mask:0xf bank_mask:0xf
    v_and_b32_dpp v22, v42, v10 row_newbcast:6 row_mask:0xf bank_mask:0xf
    v_and_b32_dpp v23, v42, v11 row_newbcast:6 row_mask:0xf bank_mask:0xf
    s_waitcnt vmcnt(22)
    s_nop 0
    v_mfma_f32_16x16x32_bf16 v[12:15], v[20:23], v[120:123], v[12:15]
    v_and_b32_dpp v16, v42, v8 row_newbcast:10 row_mask:0xf bank_mask:0xf
    v_and_b32_dpp v17, v42, v9 row_newbcast:10 row_mask:0xf bank_mask:0xf
    v_and_b32_dpp v18, v42, v10 row_newbcast:10 row_mask:0xf bank_mask:0xf
    v_and_b32_dpp v19, v42, v11 row_newbcast:10 row_mask:0xf bank_mask:0xf
    s_waitcnt vmcnt(21)
    s_nop 0
    v_mfma_f32_16x16x32_bf16 v[12:15], v[16:19], v[124:127], v[12:15]
    v_and_b32_dpp v20, v42, v8 row_newbcast:14 row_mask:0xf bank_mask:0xf
    v_and_b32_dpp v21, v42, v9 row_newbcast:14 row_mask:0xf bank_mask:0xf
    v_and_b32_dpp v22, v42, v10 row_newbcast:14 row_mask:0xf bank_mask:0xf
    v_and_b32_dpp v23, v42, v11 row_newbcast:14 row_mask:0xf bank_mask:0xf
    s_waitcnt vmcnt(20)
    s_nop 0
    v_mfma_f32_16x16x32_bf16 v[12:15], v[20:23], v[128:131], v[12:15]
    v_and_b32_dpp v16, v42, v8 row_newbcast:3 row_mask:0xf bank_mask:0xf
    v_and_b32_dpp v17, v42, v9 row_newbcast:3 row_mask:0xf bank_mask:0xf
    v_and_b32_dpp v18, v42, v10 row_newbcast:3 row_mask:0xf bank_mask:0xf
    v_and_b32_dpp v19, v42, v11 row_newbcast:3 row_mask:0xf bank_mask:0xf
    buffer_load_dwordx4 v[48:51], v2, s[28:31], s56 offen sc1
    buffer_load_dwordx4 v[52:55], v2, s[28:31], s57 offen sc1
    buffer_load_dwordx4 v[56:59], v2, s[28:31], s58 offen sc1
    s_waitcnt vmcnt(22)
    s_nop 0
    v_mfma_f32_16x16x32_bf16 v[12:15], v[16:19], v[132:135], v[12:15]
    v_and_b32_dpp v20, v42, v8 row_newbcast:7 row_mask:0xf bank_mask:0xf
    v_and_b32_dpp v21, v42, v9 row_newbcast:7 row_mask:0xf bank_mask:0xf
    v_and_b32_dpp v22, v42, v10 row_newbcast:7 row_mask:0xf bank_mask:0xf
    v_and_b32_dpp v23, v42, v11 row_newbcast:7 row_mask:0xf bank_mask:0xf
    s_waitcnt vmcnt(21)
    s_nop 0
    v_mfma_f32_16x16x32_bf16 v[12:15], v[20:23], v[136:139], v[12:15]
    v_and_b32_dpp v16, v42, v8 row_newbcast:11 row_mask:0xf bank_mask:0xf
    v_and_b32_dpp v17, v42, v9 row_newbcast:11 row_mask:0xf bank_mask:0xf
    v_and_b32_dpp v18, v42, v10 row_newbcast:11 row_mask:0xf bank_mask:0xf
    v_and_b32_dpp v19, v42, v11 row_newbcast:11 row_mask:0xf bank_mask:0xf
    s_waitcnt vmcnt(20)
    s_nop 0
    v_mfma_f32_16x16x32_bf16 v[12:15], v[16:19], v[140:143], v[12:15]
    v_and_b32_dpp v20, v42, v8 row_newbcast:15 row_mask:0xf bank_mask:0xf
    v_and_b32_dpp v21, v42, v9 row_newbcast:15 row_mask:0xf bank_mask:0xf
    v_and_b32_dpp v22, v42, v10 row_newbcast:15 row_mask:0xf bank_mask:0xf
    v_and_b32_dpp v23, v42, v11 row_newbcast:15 row_mask:0xf bank_mask:0xf
    s_waitcnt vmcnt(19)
    s_nop 0
    v_mfma_f32_16x16x32_bf16 v[12:15], v[20:23], v[144:147], v[12:15]
    v_and_b32_dpp v16, v43, v8 row_newbcast:0 row_mask:0xf bank_mask:0xf
    v_and_b32_dpp v17, v43, v9 row_newbcast:0 row_mask:0xf bank_mask:0xf
    v_and_b32_dpp v18, v43, v10 row_newbcast:0 row_mask:0xf bank_mask:0xf
    v_and_b32_dpp v19, v43, v11 row_newbcast:0 row_mask:0xf bank_mask:0xf
    s_waitcnt vmcnt(18)
    s_nop 0
    v_mfma_f32_16x16x32_bf16 v[12:15], v[16:19], v[148:151], v[12:15]
    v_and_b32_dpp v20, v43, v8 row_newbcast:4 row_mask:0xf bank_mask:0xf
    v_and_b32_dpp v21, v43, v9 row_newbcast:4 row_mask:0xf bank_mask:0xf
    v_and_b32_dpp v22, v43, v10 row_newbcast:4 row_mask:0xf bank_mask:0xf
    v_and_b32_dpp v23, v43, v11 row_newbcast:4 row_mask:0xf bank_mask:0xf
    s_waitcnt vmcnt(17)
    s_nop 0
    v_mfma_f32_16x16x32_bf16 v[12:15], v[20:23], v[152:155], v[12:15]
    v_and_b32_dpp v16, v43, v8 row_newbcast:8 row_mask:0xf bank_mask:0xf
    v_and_b32_dpp v17, v43, v9 row_newbcast:8 row_mask:0xf bank_mask:0xf
    v_and_b32_dpp v18, v43, v10 row_newbcast:8 row_mask:0xf bank_mask:0xf
    v_and_b32_dpp v19, v43, v11 row_newbcast:8 row_mask:0xf bank_mask:0xf
    s_waitcnt vmcnt(16)
    s_nop 0
    v_mfma_f32_16x16x32_bf16 v[12:15], v[16:19], v[156:159], v[12:15]
    v_and_b32_dpp v20, v43, v8 row_newbcast:12 row_mask:0xf bank_mask:0xf
    v_and_b32_dpp v21, v43, v9 row_newbcast:12 row_mask:0xf bank_mask:0xf
    v_and_b32_dpp v22, v43, v10 row_newbcast:12 row_mask:0xf bank_mask:0xf
    v_and_b32_dpp v23, v43, v11 row_newbcast:12 row_mask:0xf bank_mask:0xf
    s_waitcnt vmcnt(15)
    s_nop 0
    v_mfma_f32_16x16x32_bf16 v[12:15], v[20:23], v[160:163], v[12:15]
    v_and_b32_dpp v16, v43, v8 row_newbcast:1 row_mask:0xf bank_mask:0xf
    v_and_b32_dpp v17, v43, v9 row_newbcast:1 row_mask:0xf bank_mask:0xf
    v_and_b32_dpp v18, v43, v10 row_newbcast:1 row_mask:0xf bank_mask:0xf
    v_and_b32_dpp v19, v43, v11 row_newbcast:1 row_mask:0xf bank_mask:0xf
    s_waitcnt vmcnt(14)
    s_nop 0
    v_mfma_f32_16x16x32_bf16 v[12:15], v[16:19], v[164:167], v[12:15]
    v_and_b32_dpp v20, v43, v8 row_newbcast:5 row_mask:0xf bank_mask:0xf
    v_and_b32_dpp v21, v43, v9 row_newbcast:5 row_mask:0xf bank_mask:0xf
    v_and_b32_dpp v22, v43, v10 row_newbcast:5 row_mask:0xf bank_mask:0xf
    v_and_b32_dpp v23, v43, v11 row_newbcast:5 row_mask:0xf bank_mask:0xf
    s_waitcnt vmcnt(13)
    s_nop 0
    v_mfma_f32_16x16x32_bf16 v[12:15], v[20:23], v[168:171], v[12:15]
    v_and_b32_dpp v16, v43, v8 row_newbcast:9 row_mask:0xf bank_mask:0xf
    v_and_b32_dpp v17, v43, v9 row_newbcast:9 row_mask:0xf bank_mask:0xf
    v_and_b32_dpp v18, v43, v10 row_newbcast:9 row_mask:0xf bank_mask:0xf
    v_and_b32_dpp v19, v43, v11 row_newbcast:9 row_mask:0xf bank_mask:0xf
    s_waitcnt vmcnt(12)
    s_nop 0
    v_mfma_f32_16x16x32_bf16 v[12:15], v[16:19], v[172:175], v[12:15]
    v_and_b32_dpp v20, v43, v8 row_newbcast:13 row_mask:0xf bank_mask:0xf
    v_and_b32_dpp v21, v43, v9 row_newbcast:13 row_mask:0xf bank_mask:0xf
    v_and_b32_dpp v22, v43, v10 row_newbcast:13 row_mask:0xf bank_mask:0xf
    v_and_b32_dpp v23, v43, v11 row_newbcast:13 row_mask:0xf bank_mask:0xf
    s_waitcnt vmcnt(11)
    s_nop 0
    v_mfma_f32_16x16x32_bf16 v[12:15], v[20:23], v[176:179], v[12:15]
    v_and_b32_dpp v16, v43, v8 row_newbcast:2 row_mask:0xf bank_mask:0xf
    v_and_b32_dpp v17, v43, v9 row_newbcast:2 row_mask:0xf bank_mask:0xf
    v_and_b32_dpp v18, v43, v10 row_newbcast:2 row_mask:0xf bank_mask:0xf
    v_and_b32_dpp v19, v43, v11 row_newbcast:2 row_mask:0xf bank_mask:0xf
    s_waitcnt vmcnt(10)
    s_nop 0
    v_mfma_f32_16x16x32_bf16 v[12:15], v[16:19], v[180:183], v[12:15]
    v_and_b32_dpp v20, v43, v8 row_newbcast:6 row_mask:0xf bank_mask:0xf
    v_and_b32_dpp v21, v43, v9 row_newbcast:6 row_mask:0xf bank_mask:0xf
    v_and_b32_dpp v22, v43, v10 row_newbcast:6 row_mask:0xf bank_mask:0xf
    v_and_b32_dpp v23, v43, v11 row_newbcast:6 row_mask:0xf bank_mask:0xf
    s_waitcnt vmcnt(9)
    s_nop 0
    v_mfma_f32_16x16x32_bf16 v[12:15], v[20:23], v[184:187], v[12:15]
    v_and_b32_dpp v16, v43, v8 row_newbcast:10 row_mask:0xf bank_mask:0xf
    v_and_b32_dpp v17, v43, v9 row_newbcast:10 row_mask:0xf bank_mask:0xf
    v_and_b32_dpp v18, v43, v10 row_newbcast:10 row_mask:0xf bank_mask:0xf
    v_and_b32_dpp v19, v43, v11 row_newbcast:10 row_mask:0xf bank_mask:0xf
    s_waitcnt vmcnt(8)
    s_nop 0
    v_mfma_f32_16x16x32_bf16 v[12:15], v[16:19], v[188:191], v[12:15]
    v_and_b32_dpp v20, v43, v8 row_newbcast:14 row_mask:0xf bank_mask:0xf
    v_and_b32_dpp v21, v43, v9 row_newbcast:14 row_mask:0xf bank_mask:0xf
    v_and_b32_dpp v22, v43, v10 row_newbcast:14 row_mask:0xf bank_mask:0xf
    v_and_b32_dpp v23, v43, v11 row_newbcast:14 row_mask:0xf bank_mask:0xf
    s_waitcnt vmcnt(7)
    s_nop 0
    v_mfma_f32_16x16x32_bf16 v[12:15], v[20:23], v[192:195], v[12:15]
    v_and_b32_dpp v16, v43, v8 row_newbcast:3 row_mask:0xf bank_mask:0xf
    v_and_b32_dpp v17, v43, v9 row_newbcast:3 row_mask:0xf bank_mask:0xf
    v_and_b32_dpp v18, v43, v10 row_newbcast:3 row_mask:0xf bank_mask:0xf
    v_and_b32_dpp v19, v43, v11 row_newbcast:3 row_mask:0xf bank_mask:0xf
    s_waitcnt vmcnt(6)
    s_nop 0
    v_mfma_f32_16x16x32_bf16 v[12:15], v[16:19], v[196:199], v[12:15]
    v_and_b32_dpp v20, v43, v8 row_newbcast:7 row_mask:0xf bank_mask:0xf
    v_and_b32_dpp v21, v43, v9 row_newbcast:7 row_mask:0xf bank_mask:0xf
    v_and_b32_dpp v22, v43, v10 row_newbcast:7 row_mask:0xf bank_mask:0xf
    v_and_b32_dpp v23, v43, v11 row_newbcast:7 row_mask:0xf bank_mask:0xf
    s_waitcnt vmcnt(5)
    s_nop 0
    v_mfma_f32_16x16x32_bf16 v[12:15], v[20:23], v[200:203], v[12:15]
    v_and_b32_dpp v16, v43, v8 row_newbcast:11 row_mask:0xf bank_mask:0xf
    v_and_b32_dpp v17, v43, v9 row_newbcast:11 row_mask:0xf bank_mask:0xf
    v_and_b32_dpp v18, v43, v10 row_newbcast:11 row_mask:0xf bank_mask:0xf
    v_and_b32_dpp v19, v43, v11 row_newbcast:11 row_mask:0xf bank_mask:0xf
    s_waitcnt vmcnt(4)
    s_nop 0
    v_mfma_f32_16x16x32_bf16 v[12:15], v[16:19], v[204:207], v[12:15]
    v_and_b32_dpp v20, v43, v8 row_newbcast:15 row_mask:0xf bank_mask:0xf
    v_and_b32_dpp v21, v43, v9 row_newbcast:15 row_mask:0xf bank_mask:0xf
    v_and_b32_dpp v22, v43, v10 row_newbcast:15 row_mask:0xf bank_mask:0xf
    v_and_b32_dpp v23, v43, v11 row_newbcast:15 row_mask:0xf bank_mask:0xf
    s_waitcnt vmcnt(3)
    s_nop 0
    v_mfma_f32_16x16x32_bf16 v[12:15], v[20:23], v[208:211], v[12:15]
    s_nop 7
    v_permlane32_swap_b32 v12, v14
    v_permlane32_swap_b32 v13, v15
    v_mul_f32 v32, v12, v37
    v_mul_f32 v33, v13, v37
    buffer_store_dwordx4 v[32:35], v2, s[28:31], s36 offen sc1
    buffer_load_dwordx4 v[60:63], v2, s[28:31], s56 offen sc1
    buffer_load_dwordx4 v[64:67], v2, s[28:31], s57 offen sc1
    buffer_load_dwordx4 v[68:71], v2, s[28:31], s58 offen sc1
    s_waitcnt vmcnt(4)
    v_sub_u32 v24, v50, v1
    v_sub_u32 v25, v54, v1
    v_sub_u32 v26, v58, v1
    v_max3_u32 v24, v24, v25, v26
    v_cmp_lt_u32 vcc, 256, v24
    s_nop 4
    s_cbranch_vccz L_final0
    s_mov_b32 s50, 1
    s_waitcnt vmcnt(0)
    buffer_load_dwordx4 v[72:75], v2, s[28:31], s56 offen sc1
    buffer_load_dwordx4 v[76:79], v2, s[28:31], s57 offen sc1
    buffer_load_dwordx4 v[80:83], v2, s[28:31], s58 offen sc1
    v_sub_u32 v24, v62, v1
    v_sub_u32 v25, v66, v1
    v_sub_u32 v26, v70, v1
    v_max3_u32 v24, v24, v25, v26
    v_cmp_lt_u32 vcc, 256, v24
    s_nop 4
    s_cbranch_vccz L_final1
    s_lshl_b32 s44, s41, 2
    v_mov_b32 v29, 1
    v_mov_b32 v30, s44
    s_mov_b32 s50, 2
    s_waitcnt vmcnt(0)
    v_sub_u32 v24, v74, v1
    v_sub_u32 v25, v78, v1
    v_sub_u32 v26, v82, v1
    v_max3_u32 v24, v24, v25, v26
    v_cmp_lt_u32 vcc, 256, v24
    s_nop 4
    s_cbranch_vccz L_final2
    s_mov_b64 exec, 1
    buffer_atomic_add v29, v30, s[24:27], 0 offen sc0
    s_mov_b64 exec, -1
    s_waitcnt vmcnt(0)
    v_readfirstlane_b32 s45, v29
    s_cmp_lg_u32 s45, 3
    s_cbranch_scc1 L_fin
    buffer_load_dwordx4 v[48:51], v2, s[28:31], s56 offen sc1
    buffer_load_dwordx4 v[52:55], v2, s[28:31], s57 offen sc1
    buffer_load_dwordx4 v[56:59], v2, s[28:31], s58 offen sc1
    s_mov_b32 s50, 3
    s_waitcnt vmcnt(0)
L_final0:
    v_max3_f32 v30, v44, v51, v55
    v_max_f32 v30, v30, v59
    v_sub_f32 v16, v44, v30
    v_sub_f32 v17, v51, v30
    v_sub_f32 v18, v55, v30
    v_sub_f32 v19, v59, v30
    v_exp_f32 v16, v16
    v_exp_f32 v17, v17
    v_exp_f32 v18, v18
    v_exp_f32 v19, v19
    s_lshl_b32 s44, s41, 8
    v_add_f32 v30, v16, v18
    v_add_f32 v31, v17, v19
    v_add_f32 v30, v30, v31
    v_rcp_f32 v30, v30
    v_mul_f32 v20, v32, v16
    v_mul_f32 v21, v33, v16
    v_mul_f32 v48, v48, v17
    v_mul_f32 v49, v49, v17
    v_mul_f32 v52, v52, v18
    v_mul_f32 v53, v53, v18
    v_mul_f32 v56, v56, v19
    v_mul_f32 v57, v57, v19
    v_add_f32 v20, v20, v52
    v_add_f32 v48, v48, v56
    v_add_f32 v21, v21, v53
    v_add_f32 v49, v49, v57
    v_add_f32 v20, v20, v48
    v_add_f32 v21, v21, v49
    v_mul_f32 v20, v20, v30
    v_mul_f32 v21, v21, v30
    v_cvt_pk_bf16_f32 v20, v20, v21
    buffer_store_dword v20, v45, s[20:23], s44 offen
    s_branch L_fin
L_final1:
    v_max3_f32 v30, v44, v63, v67
    v_max_f32 v30, v30, v71
    v_sub_f32 v16, v44, v30
    v_sub_f32 v17, v63, v30
    v_sub_f32 v18, v67, v30
    v_sub_f32 v19, v71, v30
    v_exp_f32 v16, v16
    v_exp_f32 v17, v17
    v_exp_f32 v18, v18
    v_exp_f32 v19, v19
    s_lshl_b32 s44, s41, 8
    v_add_f32 v30, v16, v18
    v_add_f32 v31, v17, v19
    v_add_f32 v30, v30, v31
    v_rcp_f32 v30, v30
    v_mul_f32 v20, v32, v16
    v_mul_f32 v21, v33, v16
    v_mul_f32 v60, v60, v17
    v_mul_f32 v61, v61, v17
    v_mul_f32 v64, v64, v18
    v_mul_f32 v65, v65, v18
    v_mul_f32 v68, v68, v19
    v_mul_f32 v69, v69, v19
    v_add_f32 v20, v20, v64
    v_add_f32 v60, v60, v68
    v_add_f32 v21, v21, v65
    v_add_f32 v61, v61, v69
    v_add_f32 v20, v20, v60
    v_add_f32 v21, v21, v61
    v_mul_f32 v20, v20, v30
    v_mul_f32 v21, v21, v30
    v_cvt_pk_bf16_f32 v20, v20, v21
    buffer_store_dword v20, v45, s[20:23], s44 offen
    s_branch L_fin
L_final2:
    v_max3_f32 v30, v44, v75, v79
    v_max_f32 v30, v30, v83
    v_sub_f32 v16, v44, v30
    v_sub_f32 v17, v75, v30
    v_sub_f32 v18, v79, v30
    v_sub_f32 v19, v83, v30
    v_exp_f32 v16, v16
    v_exp_f32 v17, v17
    v_exp_f32 v18, v18
    v_exp_f32 v19, v19
    s_lshl_b32 s44, s41, 8
    v_add_f32 v30, v16, v18
    v_add_f32 v31, v17, v19
    v_add_f32 v30, v30, v31
    v_rcp_f32 v30, v30
    v_mul_f32 v20, v32, v16
    v_mul_f32 v21, v33, v16
    v_mul_f32 v72, v72, v17
    v_mul_f32 v73, v73, v17
    v_mul_f32 v76, v76, v18
    v_mul_f32 v77, v77, v18
    v_mul_f32 v80, v80, v19
    v_mul_f32 v81, v81, v19
    v_add_f32 v20, v20, v76
    v_add_f32 v72, v72, v80
    v_add_f32 v21, v21, v77
    v_add_f32 v73, v73, v81
    v_add_f32 v20, v20, v72
    v_add_f32 v21, v21, v73
    v_mul_f32 v20, v20, v30
    v_mul_f32 v21, v21, v30
    v_cvt_pk_bf16_f32 v20, v20, v21
    buffer_store_dword v20, v45, s[20:23], s44 offen
L_fin:
L_end:
s_endpgm
.section .rodata,"a"
.p2align 6
.amdhsa_kernel standalone__softmax_full_bidir__decode_kernel
  .amdhsa_next_free_vgpr 212
  .amdhsa_next_free_sgpr 96
  .amdhsa_accum_offset 212
  .amdhsa_group_segment_fixed_size 0
  .amdhsa_kernarg_size 48
  .amdhsa_user_sgpr_count 2
  .amdhsa_user_sgpr_kernarg_segment_ptr 1
  .amdhsa_system_sgpr_workgroup_id_x 1
.end_amdhsa_kernel
```
